```python
import torch

def _softmax(x, axis=-1):
    return torch.softmax(x, dim=axis)
def _gelu(x):
    return torch.nn.functional.gelu(x, approximate="tanh")
def _silu(x):
    return torch.nn.functional.silu(x)
def _sigmoid(x):
    return torch.sigmoid(x)
def _layernorm(x, axis=-1, eps=1e-5):
    m = x.mean(dim=axis, keepdim=True)
    v = x.var(dim=axis, keepdim=True, unbiased=False)
    return (x - m) / torch.sqrt(v + eps)
def _scatter_add(tgt, idx, src, axis=0):
    return tgt.clone().index_add_(axis, idx, src)
def _segment_sum(src, seg, n):
    out = torch.zeros((n,) + src.shape[1:], dtype=src.dtype)
    return out.index_add_(0, seg, src)
def _pad(x, pw):
    flat = tuple(v for pair in reversed(pw) for v in pair)
    return torch.nn.functional.pad(x, flat)

kernel_name = 'sequential_preLN__compressed_kv_cla__glu_gated_swiglu__decode'

def setup_inputs():

    _w = (lambda a: (lambda t: t.to(torch.bfloat16) if t.is_floating_point() else t)(torch.as_tensor(a)))
    def _A_setup():
        B, H, Sq, Sk, D, M = 2, 32, 1, 8192, 128, 640
        Dc = 4 * D
        return {
            "x": _w((lambda *s: torch.randn(*s, dtype=torch.bfloat16) * 0.05)(B, Sq, M)),
            "c_kv": _w((lambda *s: torch.randn(*s, dtype=torch.bfloat16) * 0.8)(B, Sk, Dc)),
            "w_q": _w((lambda *s: torch.randn(*s, dtype=torch.bfloat16) * 1.6)(M, H, D) * (M ** -0.5)),
            "w_uk": _w((lambda *s: torch.randn(*s, dtype=torch.bfloat16) * 1.6)(Dc, H, D) * (Dc ** -0.5)),
            "w_uv": _w((lambda *s: torch.randn(*s, dtype=torch.bfloat16) * 0.8)(Dc, H, D) * (Dc ** -0.5)),
            "w_o": _w((lambda *s: torch.randn(*s, dtype=torch.bfloat16) * 0.8)(H, D, M) * ((H * D) ** -0.5)),
        }
    _A_in = _A_setup()

    def _B_setup():
        B, S, D, F = 2, 1, 640, 1728
        return {
            "x": _w((lambda *s: torch.randn(*s, dtype=torch.bfloat16) * 0.05)(B, S, D)),
            "w1": _w((lambda *s: torch.randn(*s, dtype=torch.bfloat16) * 0.2)(D, F) * (2.0 / D) ** 0.5),
            "w3": _w((lambda *s: torch.randn(*s, dtype=torch.bfloat16) * 0.2)(D, F) * (2.0 / D) ** 0.5),
            "w2": _w((lambda *s: torch.randn(*s, dtype=torch.bfloat16) * 0.2)(F, D) * (2.0 / F) ** 0.5),
        }
    _B_in = _B_setup()

    return {
        "A_x": _A_in["x"],
        "A_c_kv": _A_in["c_kv"],
        "A_w_q": _A_in["w_q"],
        "A_w_uk": _A_in["w_uk"],
        "A_w_uv": _A_in["w_uv"],
        "A_w_o": _A_in["w_o"],
        "B_x": _B_in["x"],
        "B_w1": _B_in["w1"],
        "B_w3": _B_in["w3"],
        "B_w2": _B_in["w2"],
    }

def reference(A_x, A_c_kv, A_w_q, A_w_uk, A_w_uv, A_w_o, B_x, B_w1, B_w3, B_w2):
    def _A_ref(x, c_kv, w_q, w_uk, w_uv, w_o):
        B, Sq, M = x.shape[0], x.shape[1], x.shape[2]
        Sk = c_kv.shape[1]
        H, D = w_q.shape[1], w_q.shape[2]
        q = torch.einsum("bqm,mhd->bhqd", x, w_q)
        k = torch.einsum("bkc,chd->bhkd", c_kv, w_uk)
        v = torch.einsum("bkc,chd->bhkd", c_kv, w_uv)
        scores = torch.einsum("bhqd,bhkd->bhqk", q, k) * (D ** -0.5)
        off = Sk - Sq
        qi = torch.arange(Sq)[:, None]
        kj = torch.arange(Sk)[None, :]
        cmask = kj <= (qi + off)
        scores = torch.where(cmask[None, None], scores, -1e9)
        p = _softmax(scores, axis=-1)
        ctx = torch.einsum("bhqk,bhkd->bhqd", p, v)
        return torch.einsum("bhqd,hdm->bqm", ctx, w_o)

    def _B_ref(x, w1, w3, w2):
        gate = torch.einsum("bsd,df->bsf", x, w1)
        up = torch.einsum("bsd,df->bsf", x, w3)
        h = _silu(gate) * up
        out = torch.einsum("bsf,fd->bsd", h, w2)
        return out

    x = A_x
    h = x + _A_ref(_layernorm(x, axis=-1), A_c_kv, A_w_q, A_w_uk, A_w_uv, A_w_o)
    h2 = h + _B_ref(_layernorm(h, axis=-1), B_w1, B_w3, B_w2)
    return h2
```

```asm
; @launch grid=(256,1,1) block=(512,1,1) lds=163840
.amdgcn_target "amdgcn-amd-amdhsa--gfx950"
.text
.globl sequential_preLN__compressed_kv_cla__glu_gated_swiglu__decode_kernel
.p2align 8
.type sequential_preLN__compressed_kv_cla__glu_gated_swiglu__decode_kernel,@function
sequential_preLN__compressed_kv_cla__glu_gated_swiglu__decode_kernel:
    s_cmp_ge_u32 s2, 256
    s_cbranch_scc1 L_end
    s_load_dwordx16 s[8:23], s[0:1], 0
    s_load_dwordx8 s[24:31], s[0:1], 64
    s_load_dwordx2 s[32:33], s[0:1], 96
    v_lshrrev_b32 v1, 6, v0
    v_and_b32 v2, 63, v0
    v_readfirstlane_b32 s3, v1
    v_mov_b32 v3, 0
    s_waitcnt lgkmcnt(0)
    s_load_dword s101, s[30:31], 64
    s_mov_b32 s36, s32
    s_and_b32 s37, s33, 0xffff
    s_mov_b32 s38, 0x10000000
    s_mov_b32 s39, 0x00020000
    s_mov_b32 s52, s30
    s_and_b32 s53, s31, 0xffff
    s_mov_b32 s54, 0x100
    s_mov_b32 s55, 0x00020000
    s_lshr_b32 s7, s2, 6
    s_lshl_b32 s7, s7, 5
    s_and_b32 s35, s2, 31
    s_or_b32 s7, s7, s35
    s_not_b32 s35, s2
    s_and_b32 s35, s35, 32
    s_lshl_b32 s35, s35, 2
    s_or_b32 s2, s7, s35
    s_cmp_ge_u32 s2, 128
    s_cbranch_scc1 L_arole
    s_mov_b32 s4, s2
    s_and_b32 s5, s2, 31
    s_lshr_b32 s6, s2, 5
    v_lshrrev_b32 v4, 4, v2
    v_and_b32 v5, 15, v2
    s_cmp_ge_u32 s4, 32
    s_cbranch_scc1 L_w_noclr
    v_lshlrev_b32 v6, 4, v0
    v_mov_b32 v8, -1
    v_mov_b32 v9, -1
    v_mov_b32 v10, -1
    v_mov_b32 v11, -1
    s_lshl_b32 s7, s4, 13
    s_cmp_ge_u32 s4, 8
    s_cbranch_scc1 L_w_clr_lin
    v_and_b32 v6, 0x7ff, v6
    s_lshr_b32 s35, s3, 1
    s_lshl_b32 s35, s35, 14
    s_lshl_b32 s7, s4, 11
    s_add_u32 s7, s7, s35
L_w_clr_lin:
    buffer_store_dwordx4 v[8:11], v6, s[36:39], s7 offen sc1
    s_barrier
L_w_noclr:
    s_mov_b32 s48, s14
    s_and_b32 s49, s15, 0xffff
    s_mov_b32 s50, 0x400000
    s_mov_b32 s51, 0x00020000
    v_xor_b32 v228, v5, v4
    v_lshlrev_b32 v228, 4, v228
    v_lshl_add_u32 v228, v4, 13, v228
    s_lshl_b32 s67, s6, 7
    s_lshl_b32 s35, s3, 4
    s_add_u32 s67, s67, s35
    s_lshl_b32 s67, s67, 13
    s_lshl_b32 s35, s5, 8
    s_add_u32 s67, s67, s35
    s_lshl_b32 s35, s3, 12
    v_xor_b32 v18, 0, v228
    s_add_u32 m0, s35, 49152
    s_add_u32 s58, s67, 0
    buffer_load_dwordx4 v18, s[48:51], s58 offen nt lds
    v_xor_b32 v18, 64, v228
    s_add_u32 m0, s35, 50176
    s_add_u32 s58, s67, 32768
    buffer_load_dwordx4 v18, s[48:51], s58 offen nt lds
    v_xor_b32 v18, 128, v228
    s_add_u32 m0, s35, 51200
    s_add_u32 s58, s67, 65536
    buffer_load_dwordx4 v18, s[48:51], s58 offen nt lds
    v_xor_b32 v18, 192, v228
    s_add_u32 m0, s35, 52224
    s_add_u32 s58, s67, 98304
    buffer_load_dwordx4 v18, s[48:51], s58 offen nt lds
    s_cmp_ge_u32 s4, 32
    s_cbranch_scc1 L_w_noclr2
    s_waitcnt vmcnt(4)
    s_barrier
    s_cmp_lg_u32 s3, 0
    s_cbranch_scc1 L_w_noclr2
    s_mov_b32 s7, 1
    s_cmp_ge_u32 s4, 8
    s_cbranch_scc1 L_w_clr_b
    s_lshl_b32 s35, s4, 2
    s_add_u32 s35, s35, 132
    s_atomic_add s7, s[30:31], s35
    s_branch L_w_noclr2
L_w_clr_b:
    s_atomic_add s7, s[30:31], 4 glc
    s_waitcnt lgkmcnt(0)
    s_cmp_lg_u32 s7, 23
    s_cbranch_scc1 L_w_noclr2
    s_movk_i32 s7, 0x100
    s_atomic_add s7, s[30:31], 128
L_w_noclr2:
    v_bfe_u32 v200, v2, 2, 2
    v_and_b32 v201, 3, v2
    v_lshl_add_u32 v202, v4, 3, v200
    v_lshlrev_b32 v204, 4, v2
    v_and_b32 v208, 511, v204
    s_lshl_b32 s68, s5, 11
    v_lshlrev_b32 v10, 1, v4
    v_xor_b32 v10, v10, v5
    v_lshlrev_b32 v10, 4, v10
    v_lshl_add_u32 v205, v4, 8, v10
    v_add_u32 v205, 81920, v205
    v_xor_b32 v219, 128, v205
    v_bfe_u32 v11, v2, 2, 1
    v_lshl_add_u32 v206, v201, 1, v11
    v_lshlrev_b32 v10, 1, v206
    v_lshlrev_b32 v11, 8, v206
    v_add_u32 v11, 81920, v11
    v_add_u32 v12, 0, v4
    v_xor_b32 v12, v12, v10
    v_lshl_add_u32 v220, v12, 4, v11
    v_add_u32 v12, 4, v4
    v_xor_b32 v12, v12, v10
    v_lshl_add_u32 v221, v12, 4, v11
    v_add_u32 v12, 8, v4
    v_xor_b32 v12, v12, v10
    v_lshl_add_u32 v222, v12, 4, v11
    v_add_u32 v12, 12, v4
    v_xor_b32 v12, v12, v10
    v_lshl_add_u32 v223, v12, 4, v11
    v_lshlrev_b32 v11, 8, v5
    s_lshl_b32 s35, s3, 12
    s_add_u32 s35, s35, 49152
    v_add_u32 v11, s35, v11
    v_add_u32 v12, 0, v4
    v_xor_b32 v12, v12, v5
    v_lshl_add_u32 v224, v12, 4, v11
    v_add_u32 v12, 4, v4
    v_xor_b32 v12, v12, v5
    v_lshl_add_u32 v225, v12, 4, v11
    v_add_u32 v12, 8, v4
    v_xor_b32 v12, v12, v5
    v_lshl_add_u32 v226, v12, 4, v11
    v_add_u32 v12, 12, v4
    v_xor_b32 v12, v12, v5
    v_lshl_add_u32 v227, v12, 4, v11
    v_lshlrev_b32 v207, 8, v4
    v_lshl_add_u32 v207, v5, 1, v207
    s_lshl_b32 s7, s3, 5
    v_add_u32 v207, s7, v207
    v_lshlrev_b32 v209, 15, v4
    v_lshl_add_u32 v209, v5, 4, v209
    s_lshl_b32 s69, s5, 10
    s_lshl_b32 s35, s6, 8
    s_add_u32 s69, s69, s35
    s_add_u32 s69, s69, 65536
    s_waitcnt vmcnt(0)
    ds_read_b128 v[20:23], v224
    ds_read_b128 v[24:27], v225
    ds_read_b128 v[28:31], v226
    ds_read_b128 v[32:35], v227
    s_cmp_lg_u32 s3, 7
    s_cbranch_scc1 L_w_notcomm
    s_and_b32 s7, s5, 7
    s_lshl_b32 s7, s7, 2
    s_mov_b32 s34, 0
L_w_poll:
    buffer_load_dword v10, v3, s[52:55], s7 offen offset:132 sc1
    s_waitcnt vmcnt(0)
    v_cmp_eq_u32 vcc, 0, v10
    s_cbranch_vccz L_w_polld
    s_sleep 2
    s_add_u32 s34, s34, 1
    s_cmp_lt_u32 s34, 40000
    s_cbranch_scc1 L_w_poll
L_w_polld:
    s_mov_b32 s34, 0
L_w_h1:
    buffer_load_dwordx4 v[40:43], v204, s[36:39], s68 offen sc1
    buffer_load_dwordx4 v[44:47], v204, s[36:39], s68 offen offset:1024 sc1
    buffer_load_dword v10, v3, s[52:55], 0 offen offset:128 sc1
    s_waitcnt vmcnt(0)
    v_max3_u32 v11, v40, v41, v42
    v_max3_u32 v11, v11, v43, v44
    v_max3_u32 v11, v11, v45, v46
    v_max_u32 v11, v11, v47
    v_add_u32 v10, -1, v10
    v_max_u32 v11, v11, v10
    v_cmp_eq_u32 vcc, -1, v11
    s_cbranch_vccz L_w_h1d
    s_add_u32 s34, s34, 1
    s_cmp_lt_u32 s34, 40000
    s_cbranch_scc1 L_w_h1
L_w_h1d:
    ds_write_b128 v205, v[40:43]
    ds_write_b128 v219, v[44:47] offset:1024
L_w_notcomm:
    v_cmp_gt_u32 vcc, 32, v2
    s_waitcnt lgkmcnt(0)
    s_barrier
    ds_read_b128 v[40:43], v220
    ds_read_b128 v[44:47], v221
    ds_read_b128 v[48:51], v222
    ds_read_b128 v[52:55], v223
    s_mov_b32 s35, 0x3e0293ee
    s_waitcnt lgkmcnt(3)
    v_mfma_f32_16x16x32_bf16 v[60:63], v[40:43], v[20:23], 0
    s_waitcnt lgkmcnt(2)
    v_mfma_f32_16x16x32_bf16 v[60:63], v[44:47], v[24:27], v[60:63]
    s_waitcnt lgkmcnt(1)
    v_mfma_f32_16x16x32_bf16 v[60:63], v[48:51], v[28:31], v[60:63]
    s_waitcnt lgkmcnt(0)
    v_mfma_f32_16x16x32_bf16 v[60:63], v[52:55], v[32:35], v[60:63]
    s_nop 7
    v_add_f32 v60, v60, v61
    v_add_f32 v62, v62, v63
    v_add_f32 v60, v60, v62
    v_mul_f32 v60, s35, v60
    v_cvt_pk_bf16_f32 v60, v60, v60
    s_and_saveexec_b64 s[60:61], vcc
    ds_write_b16 v207, v60 offset:43520
    s_mov_b64 exec, s[60:61]
    s_waitcnt lgkmcnt(0)
    s_barrier
    s_cmp_lg_u32 s3, 0
    s_cbranch_scc1 L_w_qa_done
    ds_read_b128 v[60:63], v208 offset:43520
    s_waitcnt lgkmcnt(0)
    v_min_u32 v60, -2, v60
    v_min_u32 v61, -2, v61
    v_min_u32 v62, -2, v62
    v_min_u32 v63, -2, v63
    s_and_saveexec_b64 s[60:61], vcc
    buffer_store_dwordx4 v[60:63], v209, s[36:39], s69 offen sc1
    s_mov_b64 exec, s[60:61]
L_w_qa_done:
    s_lshr_b32 s7, s4, 3
    s_and_b32 s35, s4, 7
    s_mul_i32 s63, s35, 20
    s_add_u32 s63, s63, s7
    s_cmp_lt_u32 s35, 2
    s_cbranch_scc1 L_w_tm_done
    s_cmp_lg_u32 s35, 2
    s_cbranch_scc1 L_w_tm_b
    s_add_u32 s63, s7, 16
    s_cmp_lt_u32 s7, 4
    s_cbranch_scc1 L_w_tm_done
    s_add_u32 s63, s7, 32
    s_cmp_lt_u32 s7, 8
    s_cbranch_scc1 L_w_tm_done
    s_add_u32 s63, s7, 80
    s_cmp_lt_u32 s7, 14
    s_cbranch_scc1 L_w_tm_done
    s_movk_i32 s63, 127
    s_branch L_w_tm_done
L_w_tm_b:
    s_lshl_b32 s63, s35, 4
    s_add_u32 s63, s63, s7
    s_sub_u32 s63, s63, 8
    s_cmp_lt_u32 s35, 6
    s_cbranch_scc1 L_w_tm_done
    s_mul_i32 s63, s35, 10
    s_add_u32 s63, s63, s7
    s_add_u32 s63, s63, 34
    s_cmp_lt_u32 s7, 10
    s_cbranch_scc1 L_w_tm_done
    s_movk_i32 s63, 127
L_w_tm_done:
    s_cmp_ge_u32 s63, 114
    s_cbranch_scc1 L_w_fin
    s_cmp_lg_u32 s3, 0
    s_cbranch_scc1 L_w_ldd
    s_lshl_b32 s7, s4, 5
    s_add_u32 s7, s7, 258048
    s_mov_b32 s34, 0
L_w_ld:
    buffer_load_dword v10, v3, s[36:39], s7 offen sc1
    s_waitcnt vmcnt(0)
    v_cmp_eq_u32 vcc, -1, v10
    s_cbranch_vccz L_w_ldd
    s_sleep 2
    s_add_u32 s34, s34, 1
    s_cmp_lt_u32 s34, 40000
    s_cbranch_scc1 L_w_ld
L_w_ldd:
    s_barrier
    s_mov_b32 s4, s63
    s_cmp_ge_u32 s4, 94
    s_cbranch_scc1 L_t7
    s_cmp_ge_u32 s4, 40
    s_cbranch_scc1 L_t6
    s_mul_i32 s65, s4, 26
    s_lshr_b32 s65, s65, 8
    s_mul_i32 s7, s65, 10
    s_sub_u32 s64, s4, s7
    s_mov_b32 s44, s18
    s_and_b32 s45, s19, 0xffff
    s_mov_b32 s46, 0x500000
    s_mov_b32 s47, 0x00020000
    v_lshrrev_b32 v9, 3, v2
    v_mul_u32_u24 v9, 1280, v9
    v_and_b32 v10, 7, v2
    v_lshl_add_u32 v9, v10, 4, v9
    s_lshl_b32 s7, s65, 10
    s_lshl_b32 s35, s3, 7
    s_add_u32 s7, s7, s35
    s_mul_i32 s7, s7, 1280
    s_lshl_b32 s35, s64, 7
    s_add_u32 s7, s7, s35
    s_lshl_b32 s35, s3, 14
    s_add_u32 m0, s35, 0
    s_add_u32 s56, s7, 0
    buffer_load_dwordx4 v9, s[44:47], s56 offen nt lds
    s_add_u32 m0, s35, 1024
    s_add_u32 s56, s7, 10240
    buffer_load_dwordx4 v9, s[44:47], s56 offen nt lds
    s_add_u32 m0, s35, 2048
    s_add_u32 s56, s7, 20480
    buffer_load_dwordx4 v9, s[44:47], s56 offen nt lds
    s_add_u32 m0, s35, 3072
    s_add_u32 s56, s7, 30720
    buffer_load_dwordx4 v9, s[44:47], s56 offen nt lds
    s_add_u32 m0, s35, 4096
    s_add_u32 s56, s7, 40960
    buffer_load_dwordx4 v9, s[44:47], s56 offen nt lds
    s_add_u32 m0, s35, 5120
    s_add_u32 s56, s7, 51200
    buffer_load_dwordx4 v9, s[44:47], s56 offen nt lds
    s_add_u32 m0, s35, 6144
    s_add_u32 s56, s7, 61440
    buffer_load_dwordx4 v9, s[44:47], s56 offen nt lds
    s_add_u32 m0, s35, 7168
    s_add_u32 s56, s7, 71680
    buffer_load_dwordx4 v9, s[44:47], s56 offen nt lds
    s_add_u32 m0, s35, 8192
    s_add_u32 s56, s7, 81920
    buffer_load_dwordx4 v9, s[44:47], s56 offen nt lds
    s_add_u32 m0, s35, 9216
    s_add_u32 s56, s7, 92160
    buffer_load_dwordx4 v9, s[44:47], s56 offen nt lds
    s_add_u32 m0, s35, 10240
    s_add_u32 s56, s7, 102400
    buffer_load_dwordx4 v9, s[44:47], s56 offen nt lds
    s_add_u32 m0, s35, 11264
    s_add_u32 s56, s7, 112640
    buffer_load_dwordx4 v9, s[44:47], s56 offen nt lds
    s_add_u32 m0, s35, 12288
    s_add_u32 s56, s7, 122880
    buffer_load_dwordx4 v9, s[44:47], s56 offen nt lds
    s_add_u32 m0, s35, 13312
    s_add_u32 s56, s7, 133120
    buffer_load_dwordx4 v9, s[44:47], s56 offen nt lds
    s_add_u32 m0, s35, 14336
    s_add_u32 s56, s7, 143360
    buffer_load_dwordx4 v9, s[44:47], s56 offen nt lds
    s_add_u32 m0, s35, 15360
    s_add_u32 s56, s7, 153600
    buffer_load_dwordx4 v9, s[44:47], s56 offen nt lds
    v_lshlrev_b32 v9, 7, v202
    v_lshl_add_u32 v9, v201, 3, v9
    v_add_u32 v9, s35, v9
    v_lshlrev_b32 v10, 13, v206
    v_lshl_add_u32 v10, v4, 4, v10
    v_bfe_u32 v11, v2, 3, 1
    v_lshl_add_u32 v10, v11, 6, v10
    s_lshl_b32 s66, s65, 11
    s_lshl_b32 s35, s3, 8
    s_add_u32 s66, s66, s35
    s_add_u32 s66, s66, 163840
    v_and_b32 v12, 1, v4
    v_lshlrev_b32 v12, 8, v12
    v_lshl_add_u32 v12, v5, 2, v12
    v_lshrrev_b32 v11, 5, v2
    v_lshl_add_u32 v12, v11, 6, v12
    s_lshl_b32 s7, s3, 9
    s_add_u32 s7, s7, 131072
    v_add_u32 v12, s7, v12
    v_lshlrev_b32 v14, 2, v2
    s_and_b32 s7, s3, 1
    s_lshl_b32 s35, s7, 8
    s_add_u32 s35, s35, 131072
    v_add_u32 v13, s35, v14
    s_lshl_b32 s67, s65, 1
    s_add_u32 s67, s67, s7
    s_mul_i32 s67, s67, 2560
    s_lshl_b32 s35, s64, 8
    s_add_u32 s67, s67, s35
    s_add_u32 s67, s67, 229376
    s_waitcnt vmcnt(0)
    ds_read_b64_tr_b16 v[100:101], v9 offset:0
    ds_read_b64_tr_b16 v[102:103], v9 offset:512
    ds_read_b64_tr_b16 v[104:105], v9 offset:32
    ds_read_b64_tr_b16 v[106:107], v9 offset:544
    ds_read_b64_tr_b16 v[108:109], v9 offset:64
    ds_read_b64_tr_b16 v[110:111], v9 offset:576
    ds_read_b64_tr_b16 v[112:113], v9 offset:96
    ds_read_b64_tr_b16 v[114:115], v9 offset:608
    s_waitcnt lgkmcnt(0)
    ds_read_b64_tr_b16 v[116:117], v9 offset:4096
    ds_read_b64_tr_b16 v[118:119], v9 offset:4608
    ds_read_b64_tr_b16 v[120:121], v9 offset:4128
    ds_read_b64_tr_b16 v[122:123], v9 offset:4640
    ds_read_b64_tr_b16 v[124:125], v9 offset:4160
    ds_read_b64_tr_b16 v[126:127], v9 offset:4672
    ds_read_b64_tr_b16 v[128:129], v9 offset:4192
    ds_read_b64_tr_b16 v[130:131], v9 offset:4704
    s_waitcnt lgkmcnt(0)
    ds_read_b64_tr_b16 v[132:133], v9 offset:8192
    ds_read_b64_tr_b16 v[134:135], v9 offset:8704
    ds_read_b64_tr_b16 v[136:137], v9 offset:8224
    ds_read_b64_tr_b16 v[138:139], v9 offset:8736
    ds_read_b64_tr_b16 v[140:141], v9 offset:8256
    ds_read_b64_tr_b16 v[142:143], v9 offset:8768
    ds_read_b64_tr_b16 v[144:145], v9 offset:8288
    ds_read_b64_tr_b16 v[146:147], v9 offset:8800
    s_waitcnt lgkmcnt(0)
    ds_read_b64_tr_b16 v[148:149], v9 offset:12288
    ds_read_b64_tr_b16 v[150:151], v9 offset:12800
    ds_read_b64_tr_b16 v[152:153], v9 offset:12320
    ds_read_b64_tr_b16 v[154:155], v9 offset:12832
    ds_read_b64_tr_b16 v[156:157], v9 offset:12352
    ds_read_b64_tr_b16 v[158:159], v9 offset:12864
    ds_read_b64_tr_b16 v[160:161], v9 offset:12384
    ds_read_b64_tr_b16 v[162:163], v9 offset:12896
    s_waitcnt lgkmcnt(0)
    v_cmp_gt_u32 s[68:69], 32, v2
    s_mov_b32 s34, 0
L_w_h4:
    buffer_load_dwordx4 v[20:23], v10, s[36:39], s66 offen offset:0 sc1
    buffer_load_dwordx4 v[24:27], v10, s[36:39], s66 offen offset:128 sc1
    s_waitcnt vmcnt(0)
    v_max3_u32 v11, v20, v21, v22
    v_max3_u32 v11, v11, v23, v24
    v_max3_u32 v11, v11, v25, v26
    v_max_u32 v11, v11, v27
    v_cmp_eq_u32 vcc, -1, v11
    s_cbranch_vccz L_w_h4d
    s_add_u32 s34, s34, 1
    s_cmp_lt_u32 s34, 40000
    s_cbranch_scc1 L_w_h4
L_w_h4d:
    v_mfma_f32_16x16x32_bf16 v[60:63], v[20:23], v[100:103], 0
    v_mfma_f32_16x16x32_bf16 v[64:67], v[20:23], v[104:107], 0
    v_mfma_f32_16x16x32_bf16 v[68:71], v[20:23], v[108:111], 0
    v_mfma_f32_16x16x32_bf16 v[72:75], v[20:23], v[112:115], 0
    v_mfma_f32_16x16x32_bf16 v[76:79], v[20:23], v[116:119], 0
    v_mfma_f32_16x16x32_bf16 v[80:83], v[20:23], v[120:123], 0
    v_mfma_f32_16x16x32_bf16 v[84:87], v[20:23], v[124:127], 0
    v_mfma_f32_16x16x32_bf16 v[88:91], v[20:23], v[128:131], 0
    v_mfma_f32_16x16x32_bf16 v[60:63], v[24:27], v[132:135], v[60:63]
    v_mfma_f32_16x16x32_bf16 v[64:67], v[24:27], v[136:139], v[64:67]
    v_mfma_f32_16x16x32_bf16 v[68:71], v[24:27], v[140:143], v[68:71]
    v_mfma_f32_16x16x32_bf16 v[72:75], v[24:27], v[144:147], v[72:75]
    v_mfma_f32_16x16x32_bf16 v[76:79], v[24:27], v[148:151], v[76:79]
    v_mfma_f32_16x16x32_bf16 v[80:83], v[24:27], v[152:155], v[80:83]
    v_mfma_f32_16x16x32_bf16 v[84:87], v[24:27], v[156:159], v[84:87]
    v_mfma_f32_16x16x32_bf16 v[88:91], v[24:27], v[160:163], v[88:91]
    s_nop 0
    v_add_f32 v60, v60, v61
    v_add_f32 v62, v62, v63
    v_add_f32 v64, v64, v65
    v_add_f32 v66, v66, v67
    v_add_f32 v68, v68, v69
    v_add_f32 v70, v70, v71
    v_add_f32 v72, v72, v73
    v_add_f32 v74, v74, v75
    v_add_f32 v76, v76, v77
    v_add_f32 v78, v78, v79
    v_add_f32 v80, v80, v81
    v_add_f32 v82, v82, v83
    v_add_f32 v84, v84, v85
    v_add_f32 v86, v86, v87
    v_add_f32 v88, v88, v89
    v_add_f32 v90, v90, v91
    v_add_f32 v60, v60, v62
    v_add_f32 v64, v64, v66
    v_add_f32 v68, v68, v70
    v_add_f32 v72, v72, v74
    v_add_f32 v76, v76, v78
    v_add_f32 v80, v80, v82
    v_add_f32 v84, v84, v86
    v_add_f32 v88, v88, v90
    s_nop 1
    v_permlane32_swap_b32 v76, v64
    v_permlane32_swap_b32 v84, v72
    s_nop 0
    v_add_f32 v60, v60, v64
    v_add_f32 v80, v80, v76
    v_add_f32 v68, v68, v72
    v_add_f32 v88, v88, v84
    v_cndmask_b32 v60, v80, v60, s[68:69]
    v_cndmask_b32 v68, v88, v68, s[68:69]
    ds_write_b32 v12, v60
    ds_write_b32 v12, v68 offset:128
    s_waitcnt lgkmcnt(0)
    s_barrier
    s_cmp_ge_u32 s3, 2
    s_cbranch_scc1 L_w_fin
    ds_read_b32 v20, v13 offset:0
    ds_read_b32 v21, v13 offset:512
    ds_read_b32 v22, v13 offset:1024
    ds_read_b32 v23, v13 offset:1536
    ds_read_b32 v24, v13 offset:2048
    ds_read_b32 v25, v13 offset:2560
    ds_read_b32 v26, v13 offset:3072
    ds_read_b32 v27, v13 offset:3584
    s_waitcnt lgkmcnt(0)
    v_add_f32 v20, v20, v21
    v_add_f32 v22, v22, v23
    v_add_f32 v24, v24, v25
    v_add_f32 v26, v26, v27
    v_add_f32 v20, v20, v22
    v_add_f32 v24, v24, v26
    v_add_f32 v20, v20, v24
    v_min_u32 v20, -2, v20
    buffer_store_dword v20, v14, s[36:39], s67 offen sc1
    s_branch L_w_fin
L_t6:
    s_sub_u32 s64, s4, 40
    s_and_b32 s7, s3, 1
    s_cmp_eq_u32 s7, 0
    s_cselect_b32 s44, s22, s24
    s_cselect_b32 s45, s23, s25
    s_and_b32 s45, s45, 0xffff
    s_mov_b32 s46, 2211840
    s_mov_b32 s47, 0x00020000
    v_lshrrev_b32 v9, 2, v2
    v_mul_u32_u24 v9, 3456, v9
    v_lshl_add_u32 v9, v201, 4, v9
    s_lshr_b32 s65, s3, 1
    s_mul_i32 s7, s65, 552960
    s_lshl_b32 s35, s64, 6
    s_add_u32 s7, s7, s35
    s_mul_i32 s35, s3, 10240
    s_add_u32 m0, s35, 0
    s_add_u32 s56, s7, 0
    buffer_load_dwordx4 v9, s[44:47], s56 offen nt lds
    s_add_u32 m0, s35, 1024
    s_add_u32 s56, s7, 55296
    buffer_load_dwordx4 v9, s[44:47], s56 offen nt lds
    s_add_u32 m0, s35, 2048
    s_add_u32 s56, s7, 110592
    buffer_load_dwordx4 v9, s[44:47], s56 offen nt lds
    s_add_u32 m0, s35, 3072
    s_add_u32 s56, s7, 165888
    buffer_load_dwordx4 v9, s[44:47], s56 offen nt lds
    s_add_u32 m0, s35, 4096
    s_add_u32 s56, s7, 221184
    buffer_load_dwordx4 v9, s[44:47], s56 offen nt lds
    s_add_u32 m0, s35, 5120
    s_add_u32 s56, s7, 276480
    buffer_load_dwordx4 v9, s[44:47], s56 offen nt lds
    s_add_u32 m0, s35, 6144
    s_add_u32 s56, s7, 331776
    buffer_load_dwordx4 v9, s[44:47], s56 offen nt lds
    s_add_u32 m0, s35, 7168
    s_add_u32 s56, s7, 387072
    buffer_load_dwordx4 v9, s[44:47], s56 offen nt lds
    s_add_u32 m0, s35, 8192
    s_add_u32 s56, s7, 442368
    buffer_load_dwordx4 v9, s[44:47], s56 offen nt lds
    s_add_u32 m0, s35, 9216
    s_add_u32 s56, s7, 497664
    buffer_load_dwordx4 v9, s[44:47], s56 offen nt lds
    s_mov_b32 s40, s8
    s_and_b32 s41, s9, 0xffff
    s_mov_b32 s42, 0xa00
    s_mov_b32 s43, 0x00020000
    s_lshr_b32 s62, s3, 2
    s_and_b32 s63, s3, 3
    v_min_u32 v12, 39, v2
    v_lshlrev_b32 v13, 3, v12
    s_mul_i32 s56, s62, 1280
    s_mul_i32 s57, s63, 320
    s_add_u32 s56, s56, s57
    buffer_load_dwordx2 v[14:15], v13, s[40:43], s56 offen
    v_lshlrev_b32 v16, 2, v0
    v_mov_b32 v17, 0x3f803f80
    v_cmp_gt_u32 vcc, 320, v0
    v_add_u32 v16, 137728, v16
    s_and_saveexec_b64 s[60:61], vcc
    ds_write_b32 v16, v17
    s_mov_b64 exec, s[60:61]
    v_lshlrev_b32 v9, 6, v202
    v_lshl_add_u32 v9, v201, 3, v9
    v_add_u32 v9, s35, v9
    v_lshlrev_b32 v210, 4, v12
    s_lshl_b32 s66, s56, 1
    s_add_u32 s66, s66, 229376
    s_add_u32 s67, s66, 5120
    s_add_u32 s68, s66, 10240
    s_add_u32 s69, s66, 15360
    s_add_u32 s56, s56, 135168
    v_add_u32 v211, s56, v13
    s_lshl_b32 s7, s3, 3
    s_add_u32 s7, s7, 139264
    v_mov_b32 v212, s7
    v_and_b32 v219, 1, v4
    v_lshl_add_u32 v219, v219, 2, v212
    v_min_u32 v213, 2, v5
    v_mul_u32_u24 v213, 1280, v213
    v_lshl_add_u32 v213, v4, 4, v213
    s_mul_i32 s7, s65, 320
    s_add_u32 s7, s7, 135168
    v_add_u32 v213, s7, v213
    v_lshlrev_b32 v214, 2, v5
    s_mul_i32 s7, s3, 384
    s_add_u32 s7, s7, 131072
    v_add_u32 v214, s7, v214
    v_lshrrev_b32 v16, 5, v2
    v_and_b32 v17, 31, v2
    v_lshlrev_b32 v215, 7, v16
    v_lshl_add_u32 v215, v17, 2, v215
    v_add_u32 v215, 131072, v215
    v_lshlrev_b32 v216, 2, v17
    v_add_u32 v216, 131328, v216
    v_lshlrev_b32 v217, 5, v16
    v_add_u32 v217, 139264, v217
    v_mul_u32_u24 v218, 3456, v16
    v_lshl_add_u32 v218, v17, 1, v218
    s_lshl_b32 s64, s64, 6
    s_add_u32 s64, s64, 249856
    s_waitcnt vmcnt(0)
    ds_read_b64_tr_b16 v[100:101], v9 offset:0
    ds_read_b64_tr_b16 v[102:103], v9 offset:256
    ds_read_b64_tr_b16 v[104:105], v9 offset:32
    ds_read_b64_tr_b16 v[106:107], v9 offset:288
    s_waitcnt lgkmcnt(4)
    ds_read_b64_tr_b16 v[108:109], v9 offset:2048
    ds_read_b64_tr_b16 v[110:111], v9 offset:2304
    ds_read_b64_tr_b16 v[112:113], v9 offset:2080
    ds_read_b64_tr_b16 v[114:115], v9 offset:2336
    s_waitcnt lgkmcnt(4)
    ds_read_b64_tr_b16 v[116:117], v9 offset:4096
    ds_read_b64_tr_b16 v[118:119], v9 offset:4352
    ds_read_b64_tr_b16 v[120:121], v9 offset:4128
    ds_read_b64_tr_b16 v[122:123], v9 offset:4384
    s_waitcnt lgkmcnt(4)
    ds_read_b64_tr_b16 v[124:125], v9 offset:6144
    ds_read_b64_tr_b16 v[126:127], v9 offset:6400
    ds_read_b64_tr_b16 v[128:129], v9 offset:6176
    ds_read_b64_tr_b16 v[130:131], v9 offset:6432
    s_waitcnt lgkmcnt(4)
    ds_read_b64_tr_b16 v[132:133], v9 offset:8192
    ds_read_b64_tr_b16 v[134:135], v9 offset:8448
    ds_read_b64_tr_b16 v[136:137], v9 offset:8224
    ds_read_b64_tr_b16 v[138:139], v9 offset:8480
    s_waitcnt lgkmcnt(4)
    v_lshlrev_b32 v40, 16, v14
    v_and_b32 v41, 0xffff0000, v14
    v_lshlrev_b32 v42, 16, v15
    v_and_b32 v43, 0xffff0000, v15
    s_waitcnt lgkmcnt(0)
    s_mov_b32 s34, 0
L_w_h5:
    buffer_load_dwordx4 v[20:23], v210, s[36:39], s66 offen sc1
    buffer_load_dwordx4 v[24:27], v210, s[36:39], s67 offen sc1
    buffer_load_dwordx4 v[28:31], v210, s[36:39], s68 offen sc1
    buffer_load_dwordx4 v[32:35], v210, s[36:39], s69 offen sc1
    s_waitcnt vmcnt(0)
    v_max3_u32 v11, v20, v21, v22
    v_max3_u32 v11, v11, v23, v24
    v_max3_u32 v11, v11, v25, v26
    v_max3_u32 v11, v11, v27, v28
    v_max3_u32 v11, v11, v29, v30
    v_max3_u32 v11, v11, v31, v32
    v_max3_u32 v11, v11, v33, v34
    v_max_u32 v11, v11, v35
    v_cmp_eq_u32 vcc, -1, v11
    s_cbranch_vccz L_w_h5d
    s_add_u32 s34, s34, 1
    s_cmp_lt_u32 s34, 40000
    s_cbranch_scc1 L_w_h5
L_w_h5d:
    v_add_f32 v20, v20, v24
    v_add_f32 v28, v28, v32
    v_add_f32 v21, v21, v25
    v_add_f32 v29, v29, v33
    v_add_f32 v22, v22, v26
    v_add_f32 v30, v30, v34
    v_add_f32 v23, v23, v27
    v_add_f32 v31, v31, v35
    v_add_f32 v40, v40, v20
    v_add_f32 v41, v41, v21
    v_add_f32 v42, v42, v22
    v_add_f32 v43, v43, v23
    v_add_f32 v40, v40, v28
    v_add_f32 v41, v41, v29
    v_add_f32 v42, v42, v30
    v_add_f32 v43, v43, v31
    v_cvt_pk_bf16_f32 v44, v40, v41
    v_cvt_pk_bf16_f32 v45, v42, v43
    ds_write_b64 v211, v[44:45]
    v_lshlrev_b32 v40, 16, v44
    v_and_b32 v41, 0xffff0000, v44
    v_lshlrev_b32 v42, 16, v45
    v_and_b32 v43, 0xffff0000, v45
    s_waitcnt lgkmcnt(0)
    s_barrier
    ds_read_b128 v[20:23], v213 offset:0
    ds_read_b128 v[24:27], v213 offset:64
    ds_read_b128 v[28:31], v213 offset:128
    ds_read_b128 v[32:35], v213 offset:192
    ds_read_b128 v[36:39], v213 offset:256
    v_cmp_gt_u32 vcc, 40, v2
    v_add_f32 v46, v40, v41
    v_mul_f32 v47, v40, v40
    v_add_f32 v48, v42, v43
    v_mul_f32 v49, v42, v42
    v_fmac_f32 v47, v41, v41
    v_fmac_f32 v49, v43, v43
    v_add_f32 v46, v46, v48
    v_add_f32 v47, v47, v49
    v_cndmask_b32 v46, 0, v46, vcc
    v_cndmask_b32 v47, 0, v47, vcc
    s_waitcnt lgkmcnt(4)
    v_mfma_f32_16x16x32_bf16 v[60:63], v[20:23], v[100:103], 0
    v_mfma_f32_16x16x32_bf16 v[64:67], v[20:23], v[104:107], 0
    v_add_f32_dpp v46, v46, v46 quad_perm:[1,0,3,2] row_mask:0xf bank_mask:0xf
    v_add_f32_dpp v47, v47, v47 quad_perm:[1,0,3,2] row_mask:0xf bank_mask:0xf
    s_waitcnt lgkmcnt(3)
    v_mfma_f32_16x16x32_bf16 v[60:63], v[24:27], v[108:111], v[60:63]
    v_mfma_f32_16x16x32_bf16 v[64:67], v[24:27], v[112:115], v[64:67]
    v_add_f32_dpp v46, v46, v46 quad_perm:[2,3,0,1] row_mask:0xf bank_mask:0xf
    v_add_f32_dpp v47, v47, v47 quad_perm:[2,3,0,1] row_mask:0xf bank_mask:0xf
    s_waitcnt lgkmcnt(2)
    v_mfma_f32_16x16x32_bf16 v[60:63], v[28:31], v[116:119], v[60:63]
    v_mfma_f32_16x16x32_bf16 v[64:67], v[28:31], v[120:123], v[64:67]
    v_add_f32_dpp v46, v46, v46 row_half_mirror row_mask:0xf bank_mask:0xf
    v_add_f32_dpp v47, v47, v47 row_half_mirror row_mask:0xf bank_mask:0xf
    s_waitcnt lgkmcnt(1)
    v_mfma_f32_16x16x32_bf16 v[60:63], v[32:35], v[124:127], v[60:63]
    v_mfma_f32_16x16x32_bf16 v[64:67], v[32:35], v[128:131], v[64:67]
    v_add_f32_dpp v46, v46, v46 row_mirror row_mask:0xf bank_mask:0xf
    v_add_f32_dpp v47, v47, v47 row_mirror row_mask:0xf bank_mask:0xf
    s_waitcnt lgkmcnt(0)
    v_mfma_f32_16x16x32_bf16 v[60:63], v[36:39], v[132:135], v[60:63]
    v_mfma_f32_16x16x32_bf16 v[64:67], v[36:39], v[136:139], v[64:67]
    v_permlane16_swap_b32 v46, v47
    s_nop 0
    v_add_f32 v46, v46, v47
    v_mov_b32 v47, v46
    s_nop 1
    v_permlane32_swap_b32 v47, v46
    s_nop 0
    v_add_f32 v46, v46, v47
    ds_write_b32 v219, v46
    v_cmp_gt_u32 vcc, 16, v2
    s_and_saveexec_b64 s[60:61], vcc
    ds_write_b32 v214, v60 offset:0
    ds_write_b32 v214, v61 offset:128
    ds_write_b32 v214, v62 offset:256
    ds_write_b32 v214, v64 offset:64
    ds_write_b32 v214, v65 offset:192
    ds_write_b32 v214, v66 offset:320
    s_mov_b64 exec, s[60:61]
    s_waitcnt lgkmcnt(0)
    s_barrier
    s_cmp_lg_u32 s3, 0
    s_cbranch_scc1 L_w_fin
    ds_read_b128 v[40:43], v217
    ds_read_b128 v[44:47], v217 offset:16
    ds_read_b32 v20, v215 offset:0
    ds_read_b32 v21, v215 offset:384
    ds_read_b32 v22, v215 offset:768
    ds_read_b32 v23, v215 offset:1152
    ds_read_b32 v24, v215 offset:1536
    ds_read_b32 v25, v215 offset:1920
    ds_read_b32 v26, v215 offset:2304
    ds_read_b32 v27, v215 offset:2688
    s_waitcnt lgkmcnt(8)
    ds_read_b32 v28, v216 offset:0
    ds_read_b32 v29, v216 offset:384
    ds_read_b32 v30, v216 offset:768
    ds_read_b32 v31, v216 offset:1152
    ds_read_b32 v32, v216 offset:1536
    ds_read_b32 v33, v216 offset:1920
    ds_read_b32 v34, v216 offset:2304
    ds_read_b32 v35, v216 offset:2688
    v_add_f32 v48, v40, v42
    v_add_f32 v49, v44, v46
    v_add_f32 v50, v41, v43
    v_add_f32 v51, v45, v47
    v_add_f32 v48, v48, v49
    v_add_f32 v49, v50, v51
    v_mul_f32 v48, 0x3acccccd, v48
    v_mul_f32 v49, 0x3acccccd, v49
    v_fma_f32 v49, -v48, v48, v49
    v_max_f32 v49, 0, v49
    v_add_f32 v51, 0x3727c5ac, v49
    v_rsq_f32 v51, v51
    s_waitcnt lgkmcnt(8)
    v_add_f32 v20, v20, v22
    v_add_f32 v24, v24, v26
    v_add_f32 v21, v21, v23
    v_add_f32 v25, v25, v27
    v_add_f32 v20, v20, v24
    v_add_f32 v21, v21, v25
    s_waitcnt lgkmcnt(0)
    v_add_f32 v28, v28, v30
    v_add_f32 v32, v32, v34
    v_add_f32 v29, v29, v31
    v_add_f32 v33, v33, v35
    v_add_f32 v28, v28, v32
    v_add_f32 v29, v29, v33
    v_fma_f32 v20, -v48, v28, v20
    v_fma_f32 v21, -v48, v29, v21
    v_mul_f32 v20, v20, v51
    v_mul_f32 v21, v21, v51
    v_mul_f32 v22, 0xbfb8aa3b, v20
    v_exp_f32 v22, v22
    v_mul_f32 v20, v20, v21
    v_add_f32 v22, 1.0, v22
    v_rcp_f32 v22, v22
    s_nop 0
    v_mul_f32 v20, v20, v22
    s_nop 1
    v_mov_b32_dpp v21, v20 quad_perm:[1,1,3,3] row_mask:0xf bank_mask:0xf
    s_nop 0
    v_cvt_pk_bf16_f32 v20, v20, v21
    v_min_u32 v20, -2, v20
    s_mov_b64 s[60:61], exec
    s_mov_b32 exec_lo, 0x55555555
    s_mov_b32 exec_hi, 0x55555555
    buffer_store_dword v20, v218, s[36:39], s64 offen sc1
    s_mov_b64 exec, s[60:61]
    s_branch L_w_fin
L_t7:
    s_sub_u32 s64, s4, 94
    s_mov_b32 s44, s26
    s_and_b32 s45, s27, 0xffff
    s_mov_b32 s46, 0x21c000
    s_mov_b32 s47, 0x00020000
    v_lshrrev_b32 v9, 2, v2
    v_mul_u32_u24 v9, 1280, v9
    v_lshl_add_u32 v9, v201, 4, v9
    s_mul_i32 s7, s3, 81920
    s_lshl_b32 s35, s64, 6
    s_add_u32 s7, s7, s35
    s_lshl_b32 s35, s3, 12
    s_add_u32 m0, s35, 0
    s_add_u32 s56, s7, 0
    buffer_load_dwordx4 v9, s[44:47], s56 offen nt lds
    s_add_u32 m0, s35, 1024
    s_add_u32 s56, s7, 20480
    buffer_load_dwordx4 v9, s[44:47], s56 offen nt lds
    s_add_u32 m0, s35, 2048
    s_add_u32 s56, s7, 40960
    buffer_load_dwordx4 v9, s[44:47], s56 offen nt lds
    s_add_u32 m0, s35, 3072
    s_add_u32 s56, s7, 61440
    buffer_load_dwordx4 v9, s[44:47], s56 offen nt lds
    s_add_u32 m0, s35, 32768
    s_add_u32 s56, s7, 655360
    buffer_load_dwordx4 v9, s[44:47], s56 offen nt lds
    s_add_u32 m0, s35, 33792
    s_add_u32 s56, s7, 675840
    buffer_load_dwordx4 v9, s[44:47], s56 offen nt lds
    s_add_u32 m0, s35, 34816
    s_add_u32 s56, s7, 696320
    buffer_load_dwordx4 v9, s[44:47], s56 offen nt lds
    s_add_u32 m0, s35, 35840
    s_add_u32 s56, s7, 716800
    buffer_load_dwordx4 v9, s[44:47], s56 offen nt lds
    s_add_u32 m0, s35, 65536
    s_add_u32 s56, s7, 1310720
    buffer_load_dwordx4 v9, s[44:47], s56 offen nt lds
    s_add_u32 m0, s35, 66560
    s_add_u32 s56, s7, 1331200
    buffer_load_dwordx4 v9, s[44:47], s56 offen nt lds
    s_add_u32 m0, s35, 67584
    s_add_u32 s56, s7, 1351680
    buffer_load_dwordx4 v9, s[44:47], s56 offen nt lds
    s_add_u32 m0, s35, 68608
    s_add_u32 s56, s7, 1372160
    buffer_load_dwordx4 v9, s[44:47], s56 offen nt lds
    s_cmp_ge_u32 s3, 3
    s_cbranch_scc1 L_t7_dma_done
    s_add_u32 m0, s35, 98304
    s_add_u32 s56, s7, 1966080
    buffer_load_dwordx4 v9, s[44:47], s56 offen nt lds
    s_add_u32 m0, s35, 99328
    s_add_u32 s56, s7, 1986560
    buffer_load_dwordx4 v9, s[44:47], s56 offen nt lds
    s_add_u32 m0, s35, 100352
    s_add_u32 s56, s7, 2007040
    buffer_load_dwordx4 v9, s[44:47], s56 offen nt lds
    s_add_u32 m0, s35, 101376
    s_add_u32 s56, s7, 2027520
    buffer_load_dwordx4 v9, s[44:47], s56 offen nt lds
L_t7_dma_done:
    s_mov_b32 s40, s8
    s_and_b32 s41, s9, 0xffff
    s_mov_b32 s42, 0xa00
    s_mov_b32 s43, 0x00020000
    s_mov_b32 s48, s28
    s_and_b32 s49, s29, 0xffff
    s_mov_b32 s50, 0xa00
    s_mov_b32 s51, 0x00020000
    v_lshrrev_b32 v16, 5, v2
    v_and_b32 v17, 31, v2
    v_mul_u32_u24 v210, 2560, v16
    v_lshl_add_u32 v210, v17, 2, v210
    v_mul_u32_u24 v211, 1280, v16
    v_lshl_add_u32 v211, v17, 1, v211
    s_lshl_b32 s65, s64, 6
    buffer_load_ushort v70, v211, s[40:43], s65 offen
    buffer_load_ushort v71, v211, s[48:51], s65 offen
    s_lshl_b32 s66, s64, 7
    s_add_u32 s66, s66, 229376
    s_add_u32 s67, s66, 5120
    s_add_u32 s68, s66, 10240
    s_add_u32 s69, s66, 15360
    v_lshlrev_b32 v9, 6, v202
    v_lshl_add_u32 v9, v201, 3, v9
    v_add_u32 v9, s35, v9
    v_add_u32 v10, 0x10000, v9
    v_and_b32 v212, 1, v2
    v_mul_u32_u24 v212, 3456, v212
    v_lshl_add_u32 v212, v4, 4, v212
    v_bfe_u32 v11, v2, 1, 1
    v_lshl_add_u32 v212, v11, 6, v212
    v_bfe_u32 v11, v2, 2, 2
    s_cmp_ge_u32 s3, 3
    s_cselect_b32 s7, 2, 3
    v_cmp_ge_u32 vcc, s7, v11
    s_nop 1
    v_cndmask_b32 v11, 0, v11, vcc
    v_lshl_add_u32 v212, v11, 10, v212
    s_lshl_b32 s62, s3, 7
    s_add_u32 s62, s62, 249856
    v_lshlrev_b32 v213, 2, v5
    s_lshl_b32 s7, s3, 8
    s_add_u32 s7, s7, 131072
    v_add_u32 v213, s7, v213
    v_lshlrev_b32 v214, 2, v2
    v_add_u32 v214, 131072, v214
    v_and_b32 v11, 1, v4
    v_lshl_add_u32 v215, v11, 7, v213
    v_lshrrev_b32 v11, 1, v4
    v_lshl_add_u32 v215, v11, 6, v215
    v_mov_b32 v32, 0
    v_mov_b32 v33, 0
    v_mov_b32 v34, 0
    v_mov_b32 v35, 0
    v_mov_b32 v148, 0
    v_mov_b32 v149, 0
    v_mov_b32 v150, 0
    v_mov_b32 v151, 0
    v_mov_b32 v152, 0
    v_mov_b32 v153, 0
    v_mov_b32 v154, 0
    v_mov_b32 v155, 0
    v_mov_b32 v156, 0
    v_mov_b32 v157, 0
    v_mov_b32 v158, 0
    v_mov_b32 v159, 0
    v_mov_b32 v160, 0
    v_mov_b32 v161, 0
    v_mov_b32 v162, 0
    v_mov_b32 v163, 0
    s_waitcnt vmcnt(0)
    ds_read_b64_tr_b16 v[100:101], v9 offset:0
    ds_read_b64_tr_b16 v[102:103], v9 offset:256
    ds_read_b64_tr_b16 v[104:105], v9 offset:32
    ds_read_b64_tr_b16 v[106:107], v9 offset:288
    ds_read_b64_tr_b16 v[108:109], v9 offset:2048
    ds_read_b64_tr_b16 v[110:111], v9 offset:2304
    ds_read_b64_tr_b16 v[112:113], v9 offset:2080
    ds_read_b64_tr_b16 v[114:115], v9 offset:2336
    s_waitcnt lgkmcnt(0)
    ds_read_b64_tr_b16 v[116:117], v9 offset:32768
    ds_read_b64_tr_b16 v[118:119], v9 offset:33024
    ds_read_b64_tr_b16 v[120:121], v9 offset:32800
    ds_read_b64_tr_b16 v[122:123], v9 offset:33056
    ds_read_b64_tr_b16 v[124:125], v9 offset:34816
    ds_read_b64_tr_b16 v[126:127], v9 offset:35072
    ds_read_b64_tr_b16 v[128:129], v9 offset:34848
    ds_read_b64_tr_b16 v[130:131], v9 offset:35104
    s_waitcnt lgkmcnt(0)
    ds_read_b64_tr_b16 v[132:133], v10 offset:0
    ds_read_b64_tr_b16 v[134:135], v10 offset:256
    ds_read_b64_tr_b16 v[136:137], v10 offset:32
    ds_read_b64_tr_b16 v[138:139], v10 offset:288
    ds_read_b64_tr_b16 v[140:141], v10 offset:2048
    ds_read_b64_tr_b16 v[142:143], v10 offset:2304
    ds_read_b64_tr_b16 v[144:145], v10 offset:2080
    ds_read_b64_tr_b16 v[146:147], v10 offset:2336
    s_waitcnt lgkmcnt(0)
    s_cmp_ge_u32 s3, 3
    s_cbranch_scc1 L_t7_frag_done
    ds_read_b64_tr_b16 v[148:149], v10 offset:32768
    ds_read_b64_tr_b16 v[150:151], v10 offset:33024
    ds_read_b64_tr_b16 v[152:153], v10 offset:32800
    ds_read_b64_tr_b16 v[154:155], v10 offset:33056
    ds_read_b64_tr_b16 v[156:157], v10 offset:34816
    ds_read_b64_tr_b16 v[158:159], v10 offset:35072
    ds_read_b64_tr_b16 v[160:161], v10 offset:34848
    ds_read_b64_tr_b16 v[162:163], v10 offset:35104
    s_waitcnt lgkmcnt(0)
L_t7_frag_done:
    s_cmp_lg_u32 s3, 0
    s_cbranch_scc1 L_w_s7_noh
    s_mov_b32 s34, 0
L_w_h5b:
    buffer_load_dword v72, v210, s[36:39], s66 offen sc1
    buffer_load_dword v73, v210, s[36:39], s67 offen sc1
    buffer_load_dword v74, v210, s[36:39], s68 offen sc1
    buffer_load_dword v75, v210, s[36:39], s69 offen sc1
    s_waitcnt vmcnt(0)
    v_max3_u32 v11, v72, v73, v74
    v_max_u32 v11, v11, v75
    v_cmp_eq_u32 vcc, -1, v11
    s_cbranch_vccz L_w_h5bd
    s_sleep 1
    s_add_u32 s34, s34, 1
    s_cmp_lt_u32 s34, 40000
    s_cbranch_scc1 L_w_h5b
L_w_h5bd:
    v_lshlrev_b32 v70, 16, v70
    v_add_f32 v72, v72, v73
    v_add_f32 v74, v74, v75
    v_add_f32 v70, v70, v72
    v_add_f32 v70, v70, v74
    v_cvt_pk_bf16_f32 v70, v70, v70
    v_and_b32 v70, 0xffff0000, v70
L_w_s7_noh:
    v_cmp_eq_u32 s[44:45], 0, v4
    v_cmp_eq_u32 s[46:47], 1, v4
    v_cmp_eq_u32 s[66:67], 2, v4
    v_cmp_eq_u32 s[68:69], 3, v4
    s_mov_b32 s34, 0
L_w_h6:
    buffer_load_dwordx4 v[20:23], v212, s[36:39], s62 offen sc1
    s_waitcnt vmcnt(0)
    v_max3_u32 v11, v20, v21, v22
    v_max_u32 v11, v11, v23
    v_cmp_eq_u32 vcc, -1, v11
    s_cbranch_vccz L_w_h6d
    s_add_u32 s34, s34, 1
    s_cmp_lt_u32 s34, 40000
    s_cbranch_scc1 L_w_h6
L_w_h6d:
    v_mfma_f32_16x16x32_bf16 v[24:27], v[20:23], v[100:103], 0
    v_mfma_f32_16x16x32_bf16 v[28:31], v[20:23], v[104:107], 0
    v_mfma_f32_16x16x32_bf16 v[32:35], v[20:23], v[108:111], 0
    v_mfma_f32_16x16x32_bf16 v[36:39], v[20:23], v[112:115], 0
    v_mfma_f32_16x16x32_bf16 v[40:43], v[20:23], v[116:119], 0
    v_mfma_f32_16x16x32_bf16 v[44:47], v[20:23], v[120:123], 0
    v_mfma_f32_16x16x32_bf16 v[48:51], v[20:23], v[124:127], 0
    v_mfma_f32_16x16x32_bf16 v[52:55], v[20:23], v[128:131], 0
    v_mfma_f32_16x16x32_bf16 v[56:59], v[20:23], v[132:135], 0
    v_mfma_f32_16x16x32_bf16 v[60:63], v[20:23], v[136:139], 0
    v_mfma_f32_16x16x32_bf16 v[64:67], v[20:23], v[140:143], 0
    v_mfma_f32_16x16x32_bf16 v[80:83], v[20:23], v[144:147], 0
    v_mfma_f32_16x16x32_bf16 v[84:87], v[20:23], v[148:151], 0
    v_mfma_f32_16x16x32_bf16 v[88:91], v[20:23], v[152:155], 0
    v_mfma_f32_16x16x32_bf16 v[92:95], v[20:23], v[156:159], 0
    v_mfma_f32_16x16x32_bf16 v[96:99], v[20:23], v[160:163], 0
    s_nop 1
    v_add_f32 v24, v24, v34
    v_add_f32 v25, v25, v35
    v_add_f32 v28, v28, v38
    v_add_f32 v29, v29, v39
    v_add_f32 v40, v40, v50
    v_add_f32 v41, v41, v51
    v_add_f32 v44, v44, v54
    v_add_f32 v45, v45, v55
    v_add_f32 v56, v56, v66
    v_add_f32 v57, v57, v67
    v_add_f32 v60, v60, v82
    v_add_f32 v61, v61, v83
    v_add_f32 v84, v84, v94
    v_add_f32 v85, v85, v95
    v_add_f32 v88, v88, v98
    v_add_f32 v89, v89, v99
    v_cndmask_b32 v24, v24, v40, s[46:47]
    v_cndmask_b32 v24, v24, v56, s[66:67]
    v_cndmask_b32 v24, v24, v84, s[68:69]
    v_cndmask_b32 v25, v25, v41, s[46:47]
    v_cndmask_b32 v25, v25, v57, s[66:67]
    v_cndmask_b32 v25, v25, v85, s[68:69]
    v_cndmask_b32 v28, v28, v44, s[46:47]
    v_cndmask_b32 v28, v28, v60, s[66:67]
    v_cndmask_b32 v28, v28, v88, s[68:69]
    v_cndmask_b32 v29, v29, v45, s[46:47]
    v_cndmask_b32 v29, v29, v61, s[66:67]
    v_cndmask_b32 v29, v29, v89, s[68:69]
    s_nop 1
    v_permlane32_swap_b32 v24, v28
    v_permlane32_swap_b32 v25, v29
    s_nop 0
    v_add_f32 v24, v24, v28
    v_add_f32 v25, v25, v29
    s_nop 1
    v_permlane16_swap_b32 v24, v25
    s_nop 0
    v_add_f32 v24, v24, v25
    ds_write_b32 v215, v24
    s_waitcnt lgkmcnt(0)
    s_barrier
    s_cmp_lg_u32 s3, 0
    s_cbranch_scc1 L_w_fin
    ds_read_b32 v20, v214 offset:0
    ds_read_b32 v21, v214 offset:256
    ds_read_b32 v22, v214 offset:512
    ds_read_b32 v23, v214 offset:768
    ds_read_b32 v24, v214 offset:1024
    ds_read_b32 v25, v214 offset:1280
    ds_read_b32 v26, v214 offset:1536
    ds_read_b32 v27, v214 offset:1792
    s_waitcnt lgkmcnt(0)
    v_add_f32 v20, v20, v21
    v_add_f32 v22, v22, v23
    v_add_f32 v24, v24, v25
    v_add_f32 v26, v26, v27
    v_add_f32 v20, v20, v22
    v_add_f32 v24, v24, v26
    v_add_f32 v20, v20, v70
    v_add_f32 v20, v20, v24
    v_cvt_pk_bf16_f32 v20, v20, v20
    buffer_store_short v20, v211, s[48:51], s65 offen
L_w_fin:
    s_endpgm
L_arole:
    s_sub_u32 s4, s2, 128
    s_bfe_u32 s62, s4, 0x10002
    s_lshr_b32 s63, s4, 3
    s_lshl_b32 s63, s63, 2
    s_and_b32 s7, s4, 3
    s_or_b32 s63, s63, s7
    s_lshl_b32 s99, s62, 6
    s_or_b32 s99, s99, s63
    s_and_b32 s5, s4, 31
    s_lshr_b32 s6, s4, 5
    s_mov_b32 s48, s8
    s_and_b32 s49, s9, 0xffff
    s_mov_b32 s50, 0xa00
    s_mov_b32 s51, 0x00020000
    s_mov_b32 s44, s12
    s_and_b32 s45, s13, 0xffff
    s_mov_b32 s46, 0x500000
    s_mov_b32 s47, 0x00020000
    s_mov_b32 s40, s10
    s_and_b32 s41, s11, 0xffff
    s_mov_b32 s42, 0x1000000
    s_mov_b32 s43, 0x00020000
    v_lshrrev_b32 v4, 4, v2
    v_and_b32 v5, 15, v2
    v_lshlrev_b32 v6, 4, v2
    v_lshlrev_b32 v19, 2, v2
    s_cmp_ge_u32 s3, 2
    s_cbranch_scc1 L_a_nox
    s_mul_i32 s7, s3, 1280
    buffer_load_dword v12, v19, s[48:51], s7 offen offset:0
    buffer_load_dword v13, v19, s[48:51], s7 offen offset:256
    buffer_load_dword v14, v19, s[48:51], s7 offen offset:512
    buffer_load_dword v15, v19, s[48:51], s7 offen offset:768
    buffer_load_dword v16, v19, s[48:51], s7 offen offset:1024
L_a_nox:
    v_lshlrev_b32 v7, 4, v5
    v_lshlrev_b32 v18, 5, v4
    v_xor_b32 v7, v7, v18
    v_lshl_add_u32 v7, v4, 13, v7
    s_mul_i32 s56, s6, 1310720
    s_lshl_b32 s7, s5, 8
    s_add_u32 s56, s56, s7
    s_mul_i32 s57, s3, 20
    s_add_u32 s58, s57, 0
    s_lshl_b32 s59, s58, 4
    s_and_b32 s59, s59, 128
    v_xor_b32 v18, s59, v7
    s_lshl_b32 s59, s58, 8
    s_add_u32 m0, s59, 90112
    s_lshl_b32 s58, s58, 13
    s_add_u32 s58, s58, s56
    buffer_load_dwordx4 v18, s[44:47], s58 offen nt lds
    s_add_u32 s58, s57, 4
    s_lshl_b32 s59, s58, 4
    s_and_b32 s59, s59, 128
    v_xor_b32 v18, s59, v7
    s_lshl_b32 s59, s58, 8
    s_add_u32 m0, s59, 90112
    s_lshl_b32 s58, s58, 13
    s_add_u32 s58, s58, s56
    buffer_load_dwordx4 v18, s[44:47], s58 offen nt lds
    s_add_u32 s58, s57, 8
    s_lshl_b32 s59, s58, 4
    s_and_b32 s59, s59, 128
    v_xor_b32 v18, s59, v7
    s_lshl_b32 s59, s58, 8
    s_add_u32 m0, s59, 90112
    s_lshl_b32 s58, s58, 13
    s_add_u32 s58, s58, s56
    buffer_load_dwordx4 v18, s[44:47], s58 offen nt lds
    s_add_u32 s58, s57, 12
    s_lshl_b32 s59, s58, 4
    s_and_b32 s59, s59, 128
    v_xor_b32 v18, s59, v7
    s_lshl_b32 s59, s58, 8
    s_add_u32 m0, s59, 90112
    s_lshl_b32 s58, s58, 13
    s_add_u32 s58, s58, s56
    buffer_load_dwordx4 v18, s[44:47], s58 offen nt lds
    s_add_u32 s58, s57, 16
    s_lshl_b32 s59, s58, 4
    s_and_b32 s59, s59, 128
    v_xor_b32 v18, s59, v7
    s_lshl_b32 s59, s58, 8
    s_add_u32 m0, s59, 90112
    s_lshl_b32 s58, s58, 13
    s_add_u32 s58, s58, s56
    buffer_load_dwordx4 v18, s[44:47], s58 offen nt lds
    s_and_b32 s7, s3, 3
    s_lshl_b32 s7, s7, 2
    s_lshr_b32 s35, s3, 2
    s_or_b32 s7, s7, s35
    v_xor_b32 v145, s7, v2
    v_lshlrev_b32 v145, 4, v145
    v_xor_b32 v146, 32, v145
    s_lshl_b32 s64, s99, 7
    s_add_u32 s64, s64, s3
    s_lshl_b32 s64, s64, 10
    s_lshl_b32 s65, s3, 10
    s_cmp_lg_u32 s3, 7
    s_cbranch_scc1 L_a_np1
    s_and_b32 s67, s5, 7
    s_lshl_b32 s67, s67, 2
    buffer_load_dword v147, v3, s[52:55], s67 offen offset:132 sc1
L_a_np1:
    s_cmp_lg_u32 s3, 6
    s_cbranch_scc1 L_a_notouch
    buffer_load_dword v150, v3, s[40:43], s64 offen
    v_and_b32 v151, 3, v2
    v_lshlrev_b32 v151, 20, v151
    s_lshl_b32 s7, s5, 15
    s_add_u32 s7, s7, 1048576
    buffer_load_dword v152, v151, s[36:39], s7 offen sc1
    s_mov_b32 s48, s16
    s_and_b32 s49, s17, 0xffff
    s_mov_b32 s50, 0x400000
    s_mov_b32 s51, 0x00020000
    s_lshl_b32 s7, s6, 20
    buffer_load_dword v153, v3, s[48:51], s7 offen
L_a_notouch:
    s_cmp_ge_u32 s3, 2
    s_cbranch_scc1 L_a_noln
    s_waitcnt vmcnt(5)
    v_lshlrev_b32 v20, 16, v12
    v_and_b32 v21, 0xffff0000, v12
    v_lshlrev_b32 v22, 16, v13
    v_and_b32 v23, 0xffff0000, v13
    v_lshlrev_b32 v24, 16, v14
    v_and_b32 v25, 0xffff0000, v14
    v_lshlrev_b32 v26, 16, v15
    v_and_b32 v27, 0xffff0000, v15
    v_lshlrev_b32 v28, 16, v16
    v_and_b32 v29, 0xffff0000, v16
    v_add_f32 v30, v20, v21
    v_add_f32 v30, v30, v22
    v_add_f32 v30, v30, v23
    v_add_f32 v30, v30, v24
    v_add_f32 v30, v30, v25
    v_add_f32 v30, v30, v26
    v_add_f32 v30, v30, v27
    v_add_f32 v30, v30, v28
    v_add_f32 v30, v30, v29
    s_nop 1
    v_add_f32_dpp v30, v30, v30 quad_perm:[1,0,3,2] row_mask:0xf bank_mask:0xf
    s_nop 1
    v_add_f32_dpp v30, v30, v30 quad_perm:[2,3,0,1] row_mask:0xf bank_mask:0xf
    s_nop 1
    v_add_f32_dpp v30, v30, v30 row_half_mirror row_mask:0xf bank_mask:0xf
    s_nop 1
    v_add_f32_dpp v30, v30, v30 row_mirror row_mask:0xf bank_mask:0xf
    v_mov_b32 v31, v30
    s_nop 1
    v_permlane16_swap_b32 v31, v30
    s_nop 0
    v_add_f32 v30, v30, v31
    v_mov_b32 v31, v30
    s_nop 1
    v_permlane32_swap_b32 v31, v30
    s_nop 0
    v_add_f32 v30, v30, v31
    v_mul_f32 v30, 0x3acccccd, v30
    v_sub_f32 v20, v20, v30
    v_sub_f32 v21, v21, v30
    v_sub_f32 v22, v22, v30
    v_sub_f32 v23, v23, v30
    v_sub_f32 v24, v24, v30
    v_sub_f32 v25, v25, v30
    v_sub_f32 v26, v26, v30
    v_sub_f32 v27, v27, v30
    v_sub_f32 v28, v28, v30
    v_sub_f32 v29, v29, v30
    v_mul_f32 v32, v20, v20
    v_fmac_f32 v32, v21, v21
    v_fmac_f32 v32, v22, v22
    v_fmac_f32 v32, v23, v23
    v_fmac_f32 v32, v24, v24
    v_fmac_f32 v32, v25, v25
    v_fmac_f32 v32, v26, v26
    v_fmac_f32 v32, v27, v27
    v_fmac_f32 v32, v28, v28
    v_fmac_f32 v32, v29, v29
    s_nop 1
    v_add_f32_dpp v32, v32, v32 quad_perm:[1,0,3,2] row_mask:0xf bank_mask:0xf
    s_nop 1
    v_add_f32_dpp v32, v32, v32 quad_perm:[2,3,0,1] row_mask:0xf bank_mask:0xf
    s_nop 1
    v_add_f32_dpp v32, v32, v32 row_half_mirror row_mask:0xf bank_mask:0xf
    s_nop 1
    v_add_f32_dpp v32, v32, v32 row_mirror row_mask:0xf bank_mask:0xf
    v_mov_b32 v31, v32
    s_nop 1
    v_permlane16_swap_b32 v31, v32
    s_nop 0
    v_add_f32 v32, v32, v31
    v_mov_b32 v31, v32
    s_nop 1
    v_permlane32_swap_b32 v31, v32
    s_nop 0
    v_add_f32 v32, v32, v31
    v_mov_b32 v33, 0x3727c5ac
    v_fmac_f32 v33, 0x3acccccd, v32
    v_rsq_f32 v33, v33
    s_nop 0
    v_mul_f32 v20, v20, v33
    v_mul_f32 v21, v21, v33
    v_mul_f32 v22, v22, v33
    v_mul_f32 v23, v23, v33
    v_mul_f32 v24, v24, v33
    v_mul_f32 v25, v25, v33
    v_mul_f32 v26, v26, v33
    v_mul_f32 v27, v27, v33
    v_mul_f32 v28, v28, v33
    v_mul_f32 v29, v29, v33
    v_cvt_pk_bf16_f32 v12, v20, v21
    v_cvt_pk_bf16_f32 v13, v22, v23
    v_cvt_pk_bf16_f32 v14, v24, v25
    v_cvt_pk_bf16_f32 v15, v26, v27
    v_cvt_pk_bf16_f32 v16, v28, v29
    s_mul_i32 s7, s3, 1280
    s_add_u32 s7, s7, 131072
    v_add_u32 v19, s7, v19
    ds_write_b32 v19, v12 offset:0
    ds_write_b32 v19, v13 offset:256
    ds_write_b32 v19, v14 offset:512
    ds_write_b32 v19, v15 offset:768
    ds_write_b32 v19, v16 offset:1024
L_a_noln:
    v_bfe_u32 v11, v2, 2, 2
    v_and_b32 v10, 1, v4
    v_lshl_or_b32 v10, v10, 2, v11
    v_xor_b32 v10, s3, v10
    v_lshlrev_b32 v10, 5, v10
    v_lshl_add_u32 v140, v4, 3, v11
    v_lshl_add_u32 v140, v140, 8, v10
    v_and_b32 v10, 3, v2
    v_lshl_add_u32 v140, v10, 3, v140
    v_add_u32 v140, 90112, v140
    v_and_b32 v10, 1, v2
    v_mul_u32_u24 v141, 1280, v10
    v_lshl_add_u32 v141, v4, 4, v141
    s_mul_i32 s7, s6, 320
    s_add_u32 s7, s7, 131072
    v_add_u32 v141, s7, v141
    v_lshlrev_b32 v142, 8, v10
    v_lshl_add_u32 v142, v4, 3, v142
    s_lshl_b32 s35, s3, 5
    s_add_u32 s35, s35, 135168
    v_add_u32 v142, s35, v142
    v_and_b32 v144, 511, v6
    v_add_u32 v143, 135168, v144
    s_lshl_b32 s66, s5, 2
    s_add_u32 s66, s66, s6
    s_lshl_b32 s66, s66, 9
    v_cmp_gt_u32 vcc, 2, v5
    s_cmp_lg_u32 s3, 6
    s_cbranch_scc1 L_a_b1w
    s_waitcnt vmcnt(3) lgkmcnt(0)
    s_branch L_a_b1x
L_a_b1w:
    s_waitcnt vmcnt(0) lgkmcnt(0)
L_a_b1x:
    s_barrier
    ds_read_b64_tr_b16 v[20:21], v140 offset:0
    ds_read_b64_tr_b16 v[22:23], v140 offset:1024
    ds_read_b128 v[40:43], v141 offset:0
    ds_read_b64_tr_b16 v[24:25], v140 offset:8192
    ds_read_b64_tr_b16 v[26:27], v140 offset:9216
    ds_read_b128 v[44:47], v141 offset:64
    ds_read_b64_tr_b16 v[28:29], v140 offset:16384
    ds_read_b64_tr_b16 v[30:31], v140 offset:17408
    ds_read_b128 v[48:51], v141 offset:128
    ds_read_b64_tr_b16 v[32:33], v140 offset:24576
    ds_read_b64_tr_b16 v[34:35], v140 offset:25600
    ds_read_b128 v[52:55], v141 offset:192
    ds_read_b64_tr_b16 v[36:37], v140 offset:32768
    ds_read_b64_tr_b16 v[38:39], v140 offset:33792
    ds_read_b128 v[56:59], v141 offset:256
    s_add_u32 m0, s65, 0
    s_add_u32 s56, s64, 0
    buffer_load_dwordx4 v145, s[40:43], s56 offen nt lds
    s_add_u32 m0, s65, 8192
    s_add_u32 s56, s64, 8192
    buffer_load_dwordx4 v146, s[40:43], s56 offen nt lds
    s_waitcnt lgkmcnt(12)
    v_mfma_f32_16x16x32_bf16 v[60:63], v[20:23], v[40:43], 0
    s_waitcnt lgkmcnt(9)
    v_mfma_f32_16x16x32_bf16 v[60:63], v[24:27], v[44:47], v[60:63]
    s_waitcnt lgkmcnt(6)
    v_mfma_f32_16x16x32_bf16 v[60:63], v[28:31], v[48:51], v[60:63]
    s_waitcnt lgkmcnt(3)
    v_mfma_f32_16x16x32_bf16 v[60:63], v[32:35], v[52:55], v[60:63]
    s_waitcnt lgkmcnt(0)
    v_mfma_f32_16x16x32_bf16 v[60:63], v[36:39], v[56:59], v[60:63]
    s_nop 7
    v_cvt_pk_bf16_f32 v64, v60, v61
    v_cvt_pk_bf16_f32 v65, v62, v63
    s_and_saveexec_b64 s[60:61], vcc
    ds_write_b64 v142, v[64:65]
    s_mov_b64 exec, s[60:61]
    s_waitcnt lgkmcnt(0)
    s_barrier
    s_cmp_lg_u32 s3, 7
    s_cbranch_scc1 L_a_notcomm
    ds_read_b128 v[60:63], v143
    s_mov_b32 s34, 0
L_a_poll:
    v_cmp_eq_u32 vcc, 0, v147
    s_cbranch_vccz L_a_polld
    s_add_u32 s34, s34, 1
    s_cmp_ge_u32 s34, 40000
    s_cbranch_scc1 L_a_polld
    buffer_load_dword v147, v3, s[52:55], s67 offen offset:132 sc1
    s_waitcnt vmcnt(0)
    s_branch L_a_poll
L_a_polld:
    v_cmp_gt_u32 vcc, 32, v2
    s_waitcnt lgkmcnt(0)
    v_min_u32 v60, -2, v60
    v_min_u32 v61, -2, v61
    v_min_u32 v62, -2, v62
    v_min_u32 v63, -2, v63
    s_and_saveexec_b64 s[60:61], vcc
    buffer_store_dwordx4 v[60:63], v144, s[36:39], s66 offen sc1
    s_mov_b64 exec, s[60:61]
L_a_notcomm:
    s_barrier
    s_add_u32 m0, s65, 16384
    s_add_u32 s56, s64, 16384
    buffer_load_dwordx4 v145, s[40:43], s56 offen nt lds
    s_add_u32 m0, s65, 24576
    s_add_u32 s56, s64, 24576
    buffer_load_dwordx4 v146, s[40:43], s56 offen nt lds
    s_add_u32 m0, s65, 32768
    s_add_u32 s56, s64, 32768
    buffer_load_dwordx4 v145, s[40:43], s56 offen nt lds
    s_add_u32 m0, s65, 40960
    s_add_u32 s56, s64, 40960
    buffer_load_dwordx4 v146, s[40:43], s56 offen nt lds
    buffer_load_dword v7, v3, s[52:55], 0 offen offset:128 sc1
    s_add_u32 m0, s65, 49152
    s_add_u32 s56, s64, 49152
    buffer_load_dwordx4 v145, s[40:43], s56 offen nt lds
    s_add_u32 m0, s65, 57344
    s_add_u32 s56, s64, 57344
    buffer_load_dwordx4 v146, s[40:43], s56 offen nt lds
    s_add_u32 m0, s65, 65536
    s_add_u32 s56, s64, 65536
    buffer_load_dwordx4 v145, s[40:43], s56 offen nt lds
    s_add_u32 m0, s65, 73728
    s_add_u32 s56, s64, 73728
    buffer_load_dwordx4 v146, s[40:43], s56 offen nt lds
    s_add_u32 m0, s65, 81920
    s_add_u32 s56, s64, 81920
    buffer_load_dwordx4 v145, s[40:43], s56 offen nt lds
    s_add_u32 m0, s65, 90112
    s_add_u32 s56, s64, 90112
    buffer_load_dwordx4 v146, s[40:43], s56 offen nt lds
    s_add_u32 m0, s65, 98304
    s_add_u32 s56, s64, 98304
    buffer_load_dwordx4 v145, s[40:43], s56 offen nt lds
    s_add_u32 m0, s65, 106496
    s_add_u32 s56, s64, 106496
    buffer_load_dwordx4 v146, s[40:43], s56 offen nt lds
    s_add_u32 m0, s65, 114688
    s_add_u32 s56, s64, 114688
    buffer_load_dwordx4 v145, s[40:43], s56 offen nt lds
    s_add_u32 m0, s65, 122880
    s_add_u32 s56, s64, 122880
    buffer_load_dwordx4 v146, s[40:43], s56 offen nt lds
    s_waitcnt vmcnt(10)
    s_mov_b32 s34, 0
L_a_f2:
    v_cmp_eq_u32 vcc, 0, v7
    s_cbranch_vccz L_a_f2d
    s_add_u32 s34, s34, 1
    s_cmp_ge_u32 s34, 40000
    s_cbranch_scc1 L_a_f2d
    buffer_load_dword v7, v3, s[52:55], 0 offen offset:128 sc1
    s_waitcnt vmcnt(0)
    s_branch L_a_f2
L_a_f2d:
    s_barrier
    v_lshlrev_b32 v240, 4, v0
    s_lshl_b32 s66, s62, 15
    s_add_u32 s66, s66, 65536
    s_add_u32 s67, s66, 8192
    s_add_u32 s68, s66, 16384
    s_add_u32 s69, s66, 24576
    buffer_load_dwordx4 v[20:23], v240, s[36:39], s66 offen sc1
    buffer_load_dwordx4 v[24:27], v240, s[36:39], s67 offen sc1
    buffer_load_dwordx4 v[28:31], v240, s[36:39], s68 offen sc1
    buffer_load_dwordx4 v[32:35], v240, s[36:39], s69 offen sc1
    v_and_b32 v8, 3, v5
    v_lshrrev_b32 v9, 2, v5
    v_lshl_or_b32 v8, v8, 2, v9
    v_lshrrev_b32 v9, 5, v2
    v_and_b32 v17, 31, v2
    v_lshlrev_b32 v10, 10, v17
    s_and_b32 s7, s3, 3
    s_lshl_b32 s7, s7, 15
    v_add_u32 v11, 0, v9
    v_xor_b32 v11, v11, v8
    v_lshl_add_u32 v11, v11, 4, v10
    v_add_u32 v200, s7, v11
    v_add_u32 v208, 131072, v11
    v_add_u32 v11, 2, v9
    v_xor_b32 v11, v11, v8
    v_lshl_add_u32 v11, v11, 4, v10
    v_add_u32 v201, s7, v11
    v_add_u32 v209, 131072, v11
    v_add_u32 v11, 4, v9
    v_xor_b32 v11, v11, v8
    v_lshl_add_u32 v11, v11, 4, v10
    v_add_u32 v202, s7, v11
    v_add_u32 v210, 131072, v11
    v_add_u32 v11, 6, v9
    v_xor_b32 v11, v11, v8
    v_lshl_add_u32 v11, v11, 4, v10
    v_add_u32 v203, s7, v11
    v_add_u32 v211, 131072, v11
    v_add_u32 v11, 8, v9
    v_xor_b32 v11, v11, v8
    v_lshl_add_u32 v11, v11, 4, v10
    v_add_u32 v204, s7, v11
    v_add_u32 v212, 131072, v11
    v_add_u32 v11, 10, v9
    v_xor_b32 v11, v11, v8
    v_lshl_add_u32 v11, v11, 4, v10
    v_add_u32 v205, s7, v11
    v_add_u32 v213, 131072, v11
    v_add_u32 v11, 12, v9
    v_xor_b32 v11, v11, v8
    v_lshl_add_u32 v11, v11, 4, v10
    v_add_u32 v206, s7, v11
    v_add_u32 v214, 131072, v11
    v_add_u32 v11, 14, v9
    v_xor_b32 v11, v11, v8
    v_lshl_add_u32 v11, v11, 4, v10
    v_add_u32 v207, s7, v11
    v_add_u32 v215, 131072, v11
    v_bfe_u32 v11, v2, 2, 2
    v_lshrrev_b32 v12, 1, v4
    v_lshl_or_b32 v13, v11, 2, v12
    v_lshl_add_u32 v14, v12, 2, v11
    v_lshlrev_b32 v14, 10, v14
    s_lshr_b32 s7, s3, 2
    s_lshl_b32 s7, s7, 8
    v_add_u32 v14, s7, v14
    v_and_b32 v15, 1, v2
    v_lshl_add_u32 v14, v15, 3, v14
    v_and_b32 v15, 1, v4
    v_lshlrev_b32 v15, 1, v15
    v_bfe_u32 v16, v2, 1, 1
    v_or_b32 v15, v15, v16
    s_and_b32 s7, s3, 3
    s_lshl_b32 s7, s7, 2
    v_or_b32 v15, s7, v15
    v_xor_b32 v15, v15, v13
    v_xor_b32 v16, 0, v15
    v_lshl_add_u32 v216, v16, 4, v14
    v_add_u32 v217, 0x10000, v216
    v_xor_b32 v16, 2, v15
    v_lshl_add_u32 v218, v16, 4, v14
    v_add_u32 v218, 8192, v218
    v_add_u32 v219, 0x10000, v218
    s_and_b32 s7, s3, 3
    s_lshl_b32 s7, s7, 2
    s_lshr_b32 s35, s3, 2
    s_or_b32 s7, s7, s35
    v_xor_b32 v241, s7, v2
    v_lshlrev_b32 v241, 4, v241
    s_lshl_b32 s35, s3, 10
    s_add_u32 s35, s35, 131072
    v_add_u32 v241, s35, v241
    v_xor_b32 v242, 32, v241
    v_lshlrev_b32 v243, 4, v17
    v_add_u32 v243, 139264, v243
    s_and_b32 s7, s3, 3
    s_lshl_b32 s35, s7, 2
    v_add_u32 v244, s35, v243
    v_add_u32 v246, 131072, v6
    s_lshl_b32 s35, s7, 11
    v_add_u32 v245, s35, v246
    v_lshlrev_b32 v12, 9, v17
    v_lshl_add_u32 v12, v9, 3, v12
    v_add_u32 v12, 140288, v12
    s_lshl_b32 s7, s3, 2
    v_xor_b32 v13, s7, v5
    v_xor_b32 v14, 0, v13
    v_lshl_add_u32 v160, v14, 4, v12
    v_xor_b32 v14, 1, v13
    v_lshl_add_u32 v161, v14, 4, v12
    v_xor_b32 v14, 2, v13
    v_lshl_add_u32 v162, v14, 4, v12
    v_xor_b32 v14, 3, v13
    v_lshl_add_u32 v163, v14, 4, v12
    v_add_u32 v14, 0, v9
    v_add_u32 v14, s7, v14
    v_and_b32 v15, 15, v14
    v_xor_b32 v15, v15, v17
    v_lshlrev_b32 v15, 4, v15
    v_lshl_add_u32 v168, v14, 9, v15
    v_add_u32 v168, 140288, v168
    v_add_u32 v14, 2, v9
    v_add_u32 v14, s7, v14
    v_and_b32 v15, 15, v14
    v_xor_b32 v15, v15, v17
    v_lshlrev_b32 v15, 4, v15
    v_lshl_add_u32 v169, v14, 9, v15
    v_add_u32 v169, 140288, v169
    v_lshlrev_b32 v172, 16, v9
    v_and_b32 v14, 1, v4
    v_lshl_add_u32 v172, v14, 14, v172
    v_lshl_add_u32 v172, v5, 4, v172
    s_lshl_b32 s64, s62, 5
    s_add_u32 s64, s64, s7
    s_lshl_b32 s64, s64, 16
    s_lshl_b32 s56, s63, 8
    s_add_u32 s64, s64, s56
    s_add_u32 s64, s64, 1048576
    v_lshlrev_b32 v173, 3, v17
    s_lshl_b32 s65, s99, 8
    s_add_u32 s65, s65, 131072
    s_mov_b32 s44, s16
    s_and_b32 s45, s17, 0xffff
    s_mov_b32 s46, 0x400000
    s_mov_b32 s47, 0x00020000
    v_lshlrev_b32 v174, 4, v5
    v_lshlrev_b32 v14, 5, v4
    v_xor_b32 v174, v174, v14
    v_lshl_add_u32 v174, v4, 13, v174
    v_xor_b32 v175, 128, v174
    s_lshl_b32 s7, s3, 12
    s_add_u32 s7, s7, 32768
    v_add_u32 v176, s7, v6
    v_and_b32 v14, 1, v4
    v_lshl_or_b32 v14, v14, 2, v11
    v_xor_b32 v14, s3, v14
    v_lshlrev_b32 v14, 5, v14
    v_lshl_add_u32 v177, v4, 3, v11
    v_lshl_add_u32 v177, v177, 8, v14
    v_and_b32 v14, 3, v2
    v_lshl_add_u32 v177, v14, 3, v177
    v_add_u32 v177, 32768, v177
    v_and_b32 v178, 3, v2
    v_lshl_add_u32 v178, v178, 2, v4
    v_lshlrev_b32 v178, 8, v178
    v_lshlrev_b32 v179, 8, v4
    v_lshl_add_u32 v179, v5, 4, v179
    v_and_b32 v14, 3, v2
    v_lshl_add_u32 v14, v4, 2, v14
    v_lshl_add_u32 v14, v14, 2, v11
    v_lshlrev_b32 v180, 2, v14
    s_lshr_b32 s7, s3, 2
    s_lshl_b32 s7, s7, 8
    s_add_u32 s7, s7, 73728
    v_add_u32 v180, s7, v180
    s_and_b32 s35, s3, 3
    s_lshl_b32 s35, s35, 6
    s_add_u32 s7, s7, s35
    v_lshlrev_b32 v181, 4, v4
    v_add_u32 v181, s7, v181
    s_lshl_b32 s7, s3, 2
    v_add_u32 v14, s7, v4
    v_and_b32 v15, 15, v14
    v_xor_b32 v15, v15, v5
    v_lshlrev_b32 v15, 4, v15
    v_lshl_add_u32 v182, v14, 8, v15
    v_add_u32 v182, 65536, v182
    v_lshlrev_b32 v14, 8, v5
    v_add_u32 v14, 65536, v14
    v_add_u32 v15, 0, v4
    v_xor_b32 v15, v15, v5
    v_lshl_add_u32 v184, v15, 4, v14
    v_add_u32 v15, 4, v4
    v_xor_b32 v15, v15, v5
    v_lshl_add_u32 v185, v15, 4, v14
    v_add_u32 v15, 8, v4
    v_xor_b32 v15, v15, v5
    v_lshl_add_u32 v186, v15, 4, v14
    v_add_u32 v15, 12, v4
    v_xor_b32 v15, v15, v5
    v_lshl_add_u32 v187, v15, 4, v14
    v_lshlrev_b32 v188, 8, v9
    v_lshl_add_u32 v188, v5, 1, v188
    s_lshl_b32 s7, s3, 5
    s_add_u32 s7, s7, 74752
    v_add_u32 v188, s7, v188
    v_and_b32 v189, 511, v6
    v_add_u32 v189, 74752, v189
    v_lshlrev_b32 v190, 13, v4
    v_lshl_add_u32 v190, v5, 4, v190
    s_mov_b32 s34, 0
    s_waitcnt vmcnt(0)
    s_branch L_a_h2c
L_a_h2:
    s_waitcnt vmcnt(0)
L_a_h2c:
    v_max3_u32 v11, v20, v21, v22
    v_max3_u32 v11, v11, v23, v24
    v_max3_u32 v11, v11, v25, v26
    v_max3_u32 v11, v11, v27, v28
    v_max3_u32 v11, v11, v29, v30
    v_max3_u32 v11, v11, v31, v32
    v_max3_u32 v11, v11, v33, v34
    v_max_u32 v11, v11, v35
    v_cmp_eq_u32 vcc, -1, v11
    s_cbranch_vccz L_a_h2d
    s_sleep 2
    s_add_u32 s34, s34, 1
    s_cmp_ge_u32 s34, 40000
    s_cbranch_scc1 L_a_h2d
    buffer_load_dwordx4 v[20:23], v240, s[36:39], s66 offen sc1
    buffer_load_dwordx4 v[24:27], v240, s[36:39], s67 offen sc1
    buffer_load_dwordx4 v[28:31], v240, s[36:39], s68 offen sc1
    buffer_load_dwordx4 v[32:35], v240, s[36:39], s69 offen sc1
    s_branch L_a_h2
L_a_h2d:
    ds_write_b128 v241, v[20:23] offset:0
    ds_write_b128 v242, v[24:27] offset:8192
    ds_write_b128 v241, v[28:31] offset:16384
    ds_write_b128 v242, v[32:35] offset:24576
    s_lshl_b32 s59, s6, 7
    s_lshl_b32 s35, s3, 4
    s_add_u32 s59, s59, s35
    s_lshl_b32 s59, s59, 13
    s_lshl_b32 s35, s5, 8
    s_add_u32 s59, s59, s35
    s_waitcnt vmcnt(0) lgkmcnt(0)
    s_barrier
    s_cmp_ge_u32 s3, 4
    s_cbranch_scc1 L_a_s_done
    ds_read_b128 v[20:23], v200 offset:0
    ds_read_b128 v[24:27], v208 offset:0
    ds_read_b128 v[28:31], v201 offset:0
    ds_read_b128 v[32:35], v209 offset:0
    ds_read_b128 v[36:39], v202 offset:0
    ds_read_b128 v[40:43], v210 offset:0
    ds_read_b128 v[44:47], v203 offset:0
    ds_read_b128 v[48:51], v211 offset:0
    ds_read_b128 v[52:55], v204 offset:0
    ds_read_b128 v[56:59], v212 offset:0
    ds_read_b128 v[60:63], v205 offset:0
    ds_read_b128 v[64:67], v213 offset:0
    s_waitcnt lgkmcnt(10)
    v_mfma_f32_32x32x16_bf16 v[100:115], v[20:23], v[24:27], 0
    ds_read_b128 v[68:71], v206 offset:0
    ds_read_b128 v[72:75], v214 offset:0
    s_waitcnt lgkmcnt(10)
    v_mfma_f32_32x32x16_bf16 v[100:115], v[28:31], v[32:35], v[100:115]
    ds_read_b128 v[76:79], v207 offset:0
    ds_read_b128 v[80:83], v215 offset:0
    s_waitcnt lgkmcnt(10)
    v_mfma_f32_32x32x16_bf16 v[100:115], v[36:39], v[40:43], v[100:115]
    ds_read_b128 v[20:23], v200 offset:256
    ds_read_b128 v[24:27], v208 offset:256
    s_waitcnt lgkmcnt(10)
    v_mfma_f32_32x32x16_bf16 v[100:115], v[44:47], v[48:51], v[100:115]
    ds_read_b128 v[28:31], v201 offset:256
    ds_read_b128 v[32:35], v209 offset:256
    s_waitcnt lgkmcnt(10)
    v_mfma_f32_32x32x16_bf16 v[100:115], v[52:55], v[56:59], v[100:115]
    ds_read_b128 v[36:39], v202 offset:256
    ds_read_b128 v[40:43], v210 offset:256
    s_waitcnt lgkmcnt(10)
    v_mfma_f32_32x32x16_bf16 v[100:115], v[60:63], v[64:67], v[100:115]
    ds_read_b128 v[44:47], v203 offset:256
    ds_read_b128 v[48:51], v211 offset:256
    s_waitcnt lgkmcnt(10)
    v_mfma_f32_32x32x16_bf16 v[100:115], v[68:71], v[72:75], v[100:115]
    ds_read_b128 v[52:55], v204 offset:256
    ds_read_b128 v[56:59], v212 offset:256
    s_waitcnt lgkmcnt(10)
    v_mfma_f32_32x32x16_bf16 v[100:115], v[76:79], v[80:83], v[100:115]
    ds_read_b128 v[60:63], v205 offset:256
    ds_read_b128 v[64:67], v213 offset:256
    s_waitcnt lgkmcnt(10)
    v_mfma_f32_32x32x16_bf16 v[100:115], v[20:23], v[24:27], v[100:115]
    ds_read_b128 v[68:71], v206 offset:256
    ds_read_b128 v[72:75], v214 offset:256
    s_waitcnt lgkmcnt(10)
    v_mfma_f32_32x32x16_bf16 v[100:115], v[28:31], v[32:35], v[100:115]
    ds_read_b128 v[76:79], v207 offset:256
    ds_read_b128 v[80:83], v215 offset:256
    s_waitcnt lgkmcnt(10)
    v_mfma_f32_32x32x16_bf16 v[100:115], v[36:39], v[40:43], v[100:115]
    ds_read_b128 v[20:23], v200 offset:512
    ds_read_b128 v[24:27], v208 offset:512
    s_waitcnt lgkmcnt(10)
    v_mfma_f32_32x32x16_bf16 v[100:115], v[44:47], v[48:51], v[100:115]
    ds_read_b128 v[28:31], v201 offset:512
    ds_read_b128 v[32:35], v209 offset:512
    s_waitcnt lgkmcnt(10)
    v_mfma_f32_32x32x16_bf16 v[100:115], v[52:55], v[56:59], v[100:115]
    ds_read_b128 v[36:39], v202 offset:512
    ds_read_b128 v[40:43], v210 offset:512
    s_waitcnt lgkmcnt(10)
    v_mfma_f32_32x32x16_bf16 v[100:115], v[60:63], v[64:67], v[100:115]
    ds_read_b128 v[44:47], v203 offset:512
    ds_read_b128 v[48:51], v211 offset:512
    s_waitcnt lgkmcnt(10)
    v_mfma_f32_32x32x16_bf16 v[100:115], v[68:71], v[72:75], v[100:115]
    ds_read_b128 v[52:55], v204 offset:512
    ds_read_b128 v[56:59], v212 offset:512
    s_waitcnt lgkmcnt(10)
    v_mfma_f32_32x32x16_bf16 v[100:115], v[76:79], v[80:83], v[100:115]
    ds_read_b128 v[60:63], v205 offset:512
    ds_read_b128 v[64:67], v213 offset:512
    s_waitcnt lgkmcnt(10)
    v_mfma_f32_32x32x16_bf16 v[100:115], v[20:23], v[24:27], v[100:115]
    ds_read_b128 v[68:71], v206 offset:512
    ds_read_b128 v[72:75], v214 offset:512
    s_waitcnt lgkmcnt(10)
    v_mfma_f32_32x32x16_bf16 v[100:115], v[28:31], v[32:35], v[100:115]
    ds_read_b128 v[76:79], v207 offset:512
    ds_read_b128 v[80:83], v215 offset:512
    s_waitcnt lgkmcnt(10)
    v_mfma_f32_32x32x16_bf16 v[100:115], v[36:39], v[40:43], v[100:115]
    ds_read_b128 v[20:23], v200 offset:768
    ds_read_b128 v[24:27], v208 offset:768
    s_waitcnt lgkmcnt(10)
    v_mfma_f32_32x32x16_bf16 v[100:115], v[44:47], v[48:51], v[100:115]
    ds_read_b128 v[28:31], v201 offset:768
    ds_read_b128 v[32:35], v209 offset:768
    s_waitcnt lgkmcnt(10)
    v_mfma_f32_32x32x16_bf16 v[100:115], v[52:55], v[56:59], v[100:115]
    ds_read_b128 v[36:39], v202 offset:768
    ds_read_b128 v[40:43], v210 offset:768
    s_waitcnt lgkmcnt(10)
    v_mfma_f32_32x32x16_bf16 v[100:115], v[60:63], v[64:67], v[100:115]
    ds_read_b128 v[44:47], v203 offset:768
    ds_read_b128 v[48:51], v211 offset:768
    s_waitcnt lgkmcnt(10)
    v_mfma_f32_32x32x16_bf16 v[100:115], v[68:71], v[72:75], v[100:115]
    ds_read_b128 v[52:55], v204 offset:768
    ds_read_b128 v[56:59], v212 offset:768
    s_waitcnt lgkmcnt(10)
    v_mfma_f32_32x32x16_bf16 v[100:115], v[76:79], v[80:83], v[100:115]
    ds_read_b128 v[60:63], v205 offset:768
    ds_read_b128 v[64:67], v213 offset:768
    s_waitcnt lgkmcnt(10)
    v_mfma_f32_32x32x16_bf16 v[100:115], v[20:23], v[24:27], v[100:115]
    ds_read_b128 v[68:71], v206 offset:768
    ds_read_b128 v[72:75], v214 offset:768
    s_waitcnt lgkmcnt(10)
    v_mfma_f32_32x32x16_bf16 v[100:115], v[28:31], v[32:35], v[100:115]
    ds_read_b128 v[76:79], v207 offset:768
    ds_read_b128 v[80:83], v215 offset:768
    s_waitcnt lgkmcnt(10)
    v_mfma_f32_32x32x16_bf16 v[100:115], v[36:39], v[40:43], v[100:115]
    s_waitcnt lgkmcnt(8)
    v_mfma_f32_32x32x16_bf16 v[100:115], v[44:47], v[48:51], v[100:115]
    s_waitcnt lgkmcnt(6)
    v_mfma_f32_32x32x16_bf16 v[100:115], v[52:55], v[56:59], v[100:115]
    s_waitcnt lgkmcnt(4)
    v_mfma_f32_32x32x16_bf16 v[100:115], v[60:63], v[64:67], v[100:115]
    s_waitcnt lgkmcnt(2)
    v_mfma_f32_32x32x16_bf16 v[100:115], v[68:71], v[72:75], v[100:115]
    s_waitcnt lgkmcnt(0)
    v_mfma_f32_32x32x16_bf16 v[100:115], v[76:79], v[80:83], v[100:115]
L_a_s_done:
    buffer_load_dwordx4 v[224:227], v174, s[44:47], s59 offen nt
    s_add_u32 s59, s59, 32768
    buffer_load_dwordx4 v[228:231], v174, s[44:47], s59 offen nt
    s_add_u32 s59, s59, 32768
    buffer_load_dwordx4 v[232:235], v175, s[44:47], s59 offen nt
    s_add_u32 s59, s59, 32768
    buffer_load_dwordx4 v[236:239], v175, s[44:47], s59 offen nt
    s_barrier
    s_cmp_ge_u32 s3, 4
    s_cbranch_scc1 L_a_mx_done
    s_nop 9
    v_max3_f32 v20, v100, v101, v102
    v_max3_f32 v21, v103, v104, v105
    v_max3_f32 v22, v106, v107, v108
    v_max3_f32 v23, v109, v110, v111
    v_max3_f32 v24, v112, v113, v114
    v_max3_f32 v20, v20, v21, v115
    v_max3_f32 v22, v22, v23, v24
    v_max_f32 v20, v20, v22
    v_mov_b32 v21, v20
    s_nop 1
    v_permlane32_swap_b32 v21, v20
    s_nop 0
    v_max_f32 v20, v20, v21
    ds_write_b32 v244, v20
    s_waitcnt lgkmcnt(0)
L_a_mx_done:
    s_cmp_lg_u32 s3, 7
    s_cbranch_scc1 L_a_nold
    s_lshl_b32 s7, s4, 5
    s_add_u32 s7, s7, 258048
    s_mov_b64 s[60:61], exec
    s_mov_b64 exec, 1
    buffer_store_dword v3, v3, s[36:39], s7 offen sc1
    s_mov_b64 exec, s[60:61]
L_a_nold:
    s_barrier
    s_cmp_ge_u32 s3, 4
    s_cbranch_scc1 L_a_p_done
    ds_read_b128 v[24:27], v243
    s_waitcnt lgkmcnt(0)
    v_max3_f32 v247, v24, v25, v26
    v_max_f32 v247, v247, v27
    v_sub_f32 v100, v100, v247
    v_sub_f32 v101, v101, v247
    v_exp_f32 v100, v100
    v_sub_f32 v102, v102, v247
    v_exp_f32 v101, v101
    v_sub_f32 v103, v103, v247
    v_exp_f32 v102, v102
    v_sub_f32 v104, v104, v247
    v_exp_f32 v103, v103
    v_sub_f32 v105, v105, v247
    v_exp_f32 v104, v104
    v_sub_f32 v106, v106, v247
    v_exp_f32 v105, v105
    v_sub_f32 v107, v107, v247
    v_exp_f32 v106, v106
    v_sub_f32 v108, v108, v247
    v_exp_f32 v107, v107
    v_sub_f32 v109, v109, v247
    v_exp_f32 v108, v108
    v_sub_f32 v110, v110, v247
    v_exp_f32 v109, v109
    v_sub_f32 v111, v111, v247
    v_exp_f32 v110, v110
    v_sub_f32 v112, v112, v247
    v_exp_f32 v111, v111
    v_sub_f32 v113, v113, v247
    v_exp_f32 v112, v112
    v_sub_f32 v114, v114, v247
    v_exp_f32 v113, v113
    v_sub_f32 v115, v115, v247
    v_exp_f32 v114, v114
    v_exp_f32 v115, v115
    v_cvt_pk_bf16_f32 v28, v100, v101
    v_cvt_pk_bf16_f32 v29, v102, v103
    v_cvt_pk_bf16_f32 v30, v104, v105
    v_cvt_pk_bf16_f32 v31, v106, v107
    ds_write_b128 v245, v[28:31]
    v_cvt_pk_bf16_f32 v32, v108, v109
    v_cvt_pk_bf16_f32 v33, v110, v111
    v_cvt_pk_bf16_f32 v34, v112, v113
    v_cvt_pk_bf16_f32 v35, v114, v115
    ds_write_b128 v245, v[32:35] offset:1024
    s_waitcnt lgkmcnt(0)
L_a_p_done:
    ds_read_b64_tr_b16 v[64:65], v216 offset:0
    ds_read_b64_tr_b16 v[66:67], v218 offset:0
    ds_read_b64_tr_b16 v[68:69], v216 offset:16384
    ds_read_b64_tr_b16 v[70:71], v218 offset:16384
    ds_read_b64_tr_b16 v[72:73], v216 offset:32768
    ds_read_b64_tr_b16 v[74:75], v218 offset:32768
    ds_read_b64_tr_b16 v[76:77], v216 offset:49152
    ds_read_b64_tr_b16 v[78:79], v218 offset:49152
    ds_read_b64_tr_b16 v[80:81], v217 offset:0
    ds_read_b64_tr_b16 v[82:83], v219 offset:0
    s_barrier
    ds_read_b128 v[32:35], v246 offset:0
    ds_read_b128 v[36:39], v246 offset:1024
    ds_read_b128 v[40:43], v246 offset:2048
    ds_read_b128 v[44:47], v246 offset:3072
    v_add_f32 v20, v100, v101
    v_add_f32 v21, v102, v103
    v_add_f32 v22, v104, v105
    v_add_f32 v23, v106, v107
    v_add_f32 v24, v108, v109
    v_add_f32 v25, v110, v111
    v_add_f32 v26, v112, v113
    v_add_f32 v27, v114, v115
    v_add_f32 v20, v20, v21
    v_add_f32 v21, v22, v23
    v_add_f32 v22, v24, v25
    v_add_f32 v23, v26, v27
    v_add_f32 v20, v20, v21
    v_add_f32 v22, v22, v23
    v_add_f32 v20, v20, v22
    v_mov_b32 v21, v20
    s_nop 1
    v_permlane32_swap_b32 v21, v20
    s_nop 0
    v_add_f32 v248, v20, v21
    s_waitcnt lgkmcnt(3)
    v_mfma_f32_32x32x16_bf16 v[100:115], v[64:67], v[32:35], 0
    ds_read_b128 v[48:51], v246 offset:4096
    ds_read_b64_tr_b16 v[84:85], v217 offset:16384
    ds_read_b64_tr_b16 v[86:87], v219 offset:16384
    s_waitcnt lgkmcnt(5)
    v_mfma_f32_32x32x16_bf16 v[100:115], v[68:71], v[36:39], v[100:115]
    ds_read_b128 v[52:55], v246 offset:5120
    ds_read_b64_tr_b16 v[88:89], v217 offset:32768
    ds_read_b64_tr_b16 v[90:91], v219 offset:32768
    s_waitcnt lgkmcnt(7)
    v_mfma_f32_32x32x16_bf16 v[100:115], v[72:75], v[40:43], v[100:115]
    ds_read_b128 v[56:59], v246 offset:6144
    ds_read_b64_tr_b16 v[92:93], v217 offset:49152
    ds_read_b64_tr_b16 v[94:95], v219 offset:49152
    s_waitcnt lgkmcnt(9)
    v_mfma_f32_32x32x16_bf16 v[100:115], v[76:79], v[44:47], v[100:115]
    ds_read_b128 v[60:63], v246 offset:7168
    ds_read_b64_tr_b16 v[64:65], v216 offset:512
    ds_read_b64_tr_b16 v[66:67], v218 offset:512
    s_waitcnt lgkmcnt(11)
    v_mfma_f32_32x32x16_bf16 v[100:115], v[80:83], v[48:51], v[100:115]
    ds_read_b64_tr_b16 v[68:69], v216 offset:16896
    ds_read_b64_tr_b16 v[70:71], v218 offset:16896
    s_waitcnt lgkmcnt(10)
    v_mfma_f32_32x32x16_bf16 v[100:115], v[84:87], v[52:55], v[100:115]
    ds_read_b64_tr_b16 v[72:73], v216 offset:33280
    ds_read_b64_tr_b16 v[74:75], v218 offset:33280
    s_waitcnt lgkmcnt(9)
    v_mfma_f32_32x32x16_bf16 v[100:115], v[88:91], v[56:59], v[100:115]
    ds_read_b64_tr_b16 v[76:77], v216 offset:49664
    ds_read_b64_tr_b16 v[78:79], v218 offset:49664
    s_waitcnt lgkmcnt(8)
    v_mfma_f32_32x32x16_bf16 v[100:115], v[92:95], v[60:63], v[100:115]
    ds_read_b64_tr_b16 v[80:81], v217 offset:512
    ds_read_b64_tr_b16 v[82:83], v219 offset:512
    s_waitcnt lgkmcnt(8)
    v_mfma_f32_32x32x16_bf16 v[116:131], v[64:67], v[32:35], 0
    ds_read_b64_tr_b16 v[84:85], v217 offset:16896
    ds_read_b64_tr_b16 v[86:87], v219 offset:16896
    s_waitcnt lgkmcnt(8)
    v_mfma_f32_32x32x16_bf16 v[116:131], v[68:71], v[36:39], v[116:131]
    ds_read_b64_tr_b16 v[88:89], v217 offset:33280
    ds_read_b64_tr_b16 v[90:91], v219 offset:33280
    s_waitcnt lgkmcnt(8)
    v_mfma_f32_32x32x16_bf16 v[116:131], v[72:75], v[40:43], v[116:131]
    ds_read_b64_tr_b16 v[92:93], v217 offset:49664
    ds_read_b64_tr_b16 v[94:95], v219 offset:49664
    s_nop 3
    v_cvt_pk_bf16_f32 v20, v100, v101
    v_cvt_pk_bf16_f32 v21, v102, v103
    ds_write_b64 v160, v[20:21]
    v_cvt_pk_bf16_f32 v22, v104, v105
    v_cvt_pk_bf16_f32 v23, v106, v107
    ds_write_b64 v161, v[22:23]
    v_cvt_pk_bf16_f32 v24, v108, v109
    v_cvt_pk_bf16_f32 v25, v110, v111
    ds_write_b64 v162, v[24:25]
    v_cvt_pk_bf16_f32 v26, v112, v113
    v_cvt_pk_bf16_f32 v27, v114, v115
    ds_write_b64 v163, v[26:27]
    s_waitcnt lgkmcnt(12)
    v_mfma_f32_32x32x16_bf16 v[116:131], v[76:79], v[44:47], v[116:131]
    s_waitcnt lgkmcnt(10)
    v_mfma_f32_32x32x16_bf16 v[116:131], v[80:83], v[48:51], v[116:131]
    s_waitcnt lgkmcnt(0)
    s_barrier
    ds_read_b128 v[132:135], v168
    ds_read_b128 v[136:139], v169
    v_mfma_f32_32x32x16_bf16 v[116:131], v[84:87], v[52:55], v[116:131]
    v_mfma_f32_32x32x16_bf16 v[116:131], v[88:91], v[56:59], v[116:131]
    v_mfma_f32_32x32x16_bf16 v[116:131], v[92:95], v[60:63], v[116:131]
    s_waitcnt lgkmcnt(0)
    buffer_store_dwordx4 v[132:135], v172, s[36:39], s64 offen sc1
    s_add_u32 s56, s64, 131072
    buffer_store_dwordx4 v[136:139], v172, s[36:39], s56 offen sc1
    s_cmp_ge_u32 s3, 4
    s_cbranch_scc1 L_a_ls_done
    ds_write_b32 v244, v248 offset:512
L_a_ls_done:
    s_barrier
    s_nop 4
    v_cvt_pk_bf16_f32 v20, v116, v117
    v_cvt_pk_bf16_f32 v21, v118, v119
    ds_write_b64 v160, v[20:21]
    v_cvt_pk_bf16_f32 v22, v120, v121
    v_cvt_pk_bf16_f32 v23, v122, v123
    ds_write_b64 v161, v[22:23]
    v_cvt_pk_bf16_f32 v24, v124, v125
    v_cvt_pk_bf16_f32 v25, v126, v127
    ds_write_b64 v162, v[24:25]
    v_cvt_pk_bf16_f32 v26, v128, v129
    v_cvt_pk_bf16_f32 v27, v130, v131
    ds_write_b64 v163, v[26:27]
    s_waitcnt lgkmcnt(0)
    s_barrier
    ds_read_b128 v[40:43], v168
    ds_read_b128 v[44:47], v169
    ds_read_b128 v[24:27], v243 offset:512
    s_add_u32 s64, s64, 32768
    s_add_u32 s56, s64, 131072
    s_waitcnt lgkmcnt(2)
    buffer_store_dwordx4 v[40:43], v172, s[36:39], s64 offen sc1
    s_waitcnt lgkmcnt(1)
    buffer_store_dwordx4 v[44:47], v172, s[36:39], s56 offen sc1
    s_waitcnt vmcnt(4) lgkmcnt(0)
    ds_write_b128 v176, v[224:227] offset:0
    ds_write_b128 v176, v[228:231] offset:1024
    ds_write_b128 v176, v[232:235] offset:2048
    ds_write_b128 v176, v[236:239] offset:3072
    v_add_f32 v24, v24, v25
    v_add_f32 v26, v26, v27
    v_add_f32 v25, v24, v26
    v_min_u32 v24, -2, v247
    v_min_u32 v25, -2, v25
    v_cmp_gt_u32 vcc, 32, v2
    s_waitcnt vmcnt(0) lgkmcnt(0)
    s_barrier
    s_cmp_lg_u32 s3, 0
    s_cbranch_scc1 L_a_st_done
    s_and_saveexec_b64 s[60:61], vcc
    buffer_store_dwordx2 v[24:25], v173, s[36:39], s65 offen sc1
    s_mov_b64 exec, s[60:61]
L_a_st_done:
    ds_read_b64_tr_b16 v[100:101], v177 offset:0
    ds_read_b64_tr_b16 v[102:103], v177 offset:1024
    ds_read_b64_tr_b16 v[104:105], v177 offset:8192
    ds_read_b64_tr_b16 v[106:107], v177 offset:9216
    ds_read_b64_tr_b16 v[108:109], v177 offset:16384
    ds_read_b64_tr_b16 v[110:111], v177 offset:17408
    ds_read_b64_tr_b16 v[112:113], v177 offset:24576
    ds_read_b64_tr_b16 v[114:115], v177 offset:25600
    s_lshr_b32 s7, s3, 2
    s_lshl_b32 s66, s7, 14
    s_lshl_b32 s35, s5, 3
    s_add_u32 s66, s66, s35
    s_add_u32 s66, s66, 131072
    s_lshl_b32 s67, s7, 5
    s_add_u32 s67, s67, s5
    s_lshl_b32 s67, s67, 2
    s_add_u32 s67, s67, s6
    s_lshl_b32 s67, s67, 6
    s_and_b32 s57, s3, 3
    s_lshl_b32 s35, s57, 4
    s_add_u32 s67, s67, s35
    s_lshl_b32 s67, s67, 8
    s_add_u32 s67, s67, 1048576
    s_lshl_b32 s68, s6, 14
    s_lshl_b32 s35, s5, 8
    s_add_u32 s68, s68, s35
    s_add_u32 s68, s68, 163840
    s_lshl_b32 s35, s57, 12
    s_add_u32 s66, s66, s35
    s_lshl_b32 s35, s3, 3
    s_add_u32 s35, s35, 73728
    v_mov_b32 v180, s35
    s_lshr_b32 s35, s3, 2
    s_lshl_b32 s35, s35, 5
    s_add_u32 s35, s35, 73728
    v_mov_b32 v181, s35
    v_lshlrev_b32 v193, 3, v4
    v_add_u32 v193, 73728, v193
    s_mov_b32 s34, 0
L_a_h3:
    buffer_load_dwordx2 v[14:15], v178, s[36:39], s66 offen sc1
    s_waitcnt vmcnt(0)
    v_max_u32 v11, v14, v15
    v_cmp_eq_u32 vcc, -1, v11
    s_cbranch_vccz L_a_h3d
    s_sleep 1
    s_add_u32 s34, s34, 1
    s_cmp_lt_u32 s34, 40000
    s_cbranch_scc1 L_a_h3
L_a_h3d:
    buffer_load_dwordx4 v[20:23], v179, s[36:39], s67 offen offset:0 sc1
    buffer_load_dwordx4 v[24:27], v179, s[36:39], s67 offen offset:1024 sc1
    buffer_load_dwordx4 v[28:31], v179, s[36:39], s67 offen offset:2048 sc1
    buffer_load_dwordx4 v[32:35], v179, s[36:39], s67 offen offset:3072 sc1
    v_mov_b32 v16, v14
    s_nop 1
    v_max_f32_dpp v16, v16, v16 quad_perm:[1,0,3,2] row_mask:0xf bank_mask:0xf
    s_nop 1
    v_max_f32_dpp v16, v16, v16 quad_perm:[2,3,0,1] row_mask:0xf bank_mask:0xf
    v_mov_b32 v17, v16
    s_nop 1
    v_permlane16_swap_b32 v17, v16
    s_nop 0
    v_max_f32 v16, v16, v17
    v_mov_b32 v17, v16
    s_nop 1
    v_permlane32_swap_b32 v17, v16
    s_nop 0
    v_max_f32 v16, v16, v17
    v_sub_f32 v18, v14, v16
    v_exp_f32 v18, v18
    s_nop 0
    v_mul_f32 v17, v18, v15
    s_nop 1
    v_add_f32_dpp v17, v17, v17 quad_perm:[1,0,3,2] row_mask:0xf bank_mask:0xf
    s_nop 1
    v_add_f32_dpp v17, v17, v17 quad_perm:[2,3,0,1] row_mask:0xf bank_mask:0xf
    v_mov_b32 v19, v17
    s_nop 1
    v_permlane16_swap_b32 v19, v17
    s_nop 0
    v_add_f32 v17, v17, v19
    v_mov_b32 v19, v17
    s_nop 1
    v_permlane32_swap_b32 v19, v17
    s_nop 0
    v_add_f32 v17, v17, v19
    ds_write_b64 v180, v[16:17]
    s_nop 0
    v_mov_b32_dpp v40, v18 quad_perm:[0,0,0,0] row_mask:0xf bank_mask:0xf
    v_mov_b32_dpp v41, v18 quad_perm:[1,1,1,1] row_mask:0xf bank_mask:0xf
    v_mov_b32_dpp v42, v18 quad_perm:[2,2,2,2] row_mask:0xf bank_mask:0xf
    v_mov_b32_dpp v43, v18 quad_perm:[3,3,3,3] row_mask:0xf bank_mask:0xf
    s_waitcnt vmcnt(3)
    v_lshlrev_b32 v44, 16, v20
    v_and_b32 v45, 0xffff0000, v20
    v_lshlrev_b32 v46, 16, v21
    v_and_b32 v47, 0xffff0000, v21
    v_lshlrev_b32 v48, 16, v22
    v_and_b32 v49, 0xffff0000, v22
    v_lshlrev_b32 v50, 16, v23
    v_and_b32 v51, 0xffff0000, v23
    v_mul_f32 v52, v40, v44
    v_mul_f32 v53, v40, v45
    v_mul_f32 v54, v40, v46
    v_mul_f32 v55, v40, v47
    v_mul_f32 v56, v40, v48
    v_mul_f32 v57, v40, v49
    v_mul_f32 v58, v40, v50
    v_mul_f32 v59, v40, v51
    s_waitcnt vmcnt(2)
    v_lshlrev_b32 v44, 16, v24
    v_and_b32 v45, 0xffff0000, v24
    v_lshlrev_b32 v46, 16, v25
    v_and_b32 v47, 0xffff0000, v25
    v_lshlrev_b32 v48, 16, v26
    v_and_b32 v49, 0xffff0000, v26
    v_lshlrev_b32 v50, 16, v27
    v_and_b32 v51, 0xffff0000, v27
    v_fmac_f32 v52, v41, v44
    v_fmac_f32 v53, v41, v45
    v_fmac_f32 v54, v41, v46
    v_fmac_f32 v55, v41, v47
    v_fmac_f32 v56, v41, v48
    v_fmac_f32 v57, v41, v49
    v_fmac_f32 v58, v41, v50
    v_fmac_f32 v59, v41, v51
    s_waitcnt vmcnt(1)
    v_lshlrev_b32 v44, 16, v28
    v_and_b32 v45, 0xffff0000, v28
    v_lshlrev_b32 v46, 16, v29
    v_and_b32 v47, 0xffff0000, v29
    v_lshlrev_b32 v48, 16, v30
    v_and_b32 v49, 0xffff0000, v30
    v_lshlrev_b32 v50, 16, v31
    v_and_b32 v51, 0xffff0000, v31
    v_fmac_f32 v52, v42, v44
    v_fmac_f32 v53, v42, v45
    v_fmac_f32 v54, v42, v46
    v_fmac_f32 v55, v42, v47
    v_fmac_f32 v56, v42, v48
    v_fmac_f32 v57, v42, v49
    v_fmac_f32 v58, v42, v50
    v_fmac_f32 v59, v42, v51
    s_waitcnt vmcnt(0)
    v_lshlrev_b32 v44, 16, v32
    v_and_b32 v45, 0xffff0000, v32
    v_lshlrev_b32 v46, 16, v33
    v_and_b32 v47, 0xffff0000, v33
    v_lshlrev_b32 v48, 16, v34
    v_and_b32 v49, 0xffff0000, v34
    v_lshlrev_b32 v50, 16, v35
    v_and_b32 v51, 0xffff0000, v35
    v_fmac_f32 v52, v43, v44
    v_fmac_f32 v53, v43, v45
    v_fmac_f32 v54, v43, v46
    v_fmac_f32 v55, v43, v47
    v_fmac_f32 v56, v43, v48
    v_fmac_f32 v57, v43, v49
    v_fmac_f32 v58, v43, v50
    v_fmac_f32 v59, v43, v51
    v_cvt_pk_bf16_f32 v60, v52, v53
    v_cvt_pk_bf16_f32 v61, v54, v55
    v_cvt_pk_bf16_f32 v62, v56, v57
    v_cvt_pk_bf16_f32 v63, v58, v59
    ds_write_b128 v182, v[60:63]
    s_waitcnt lgkmcnt(0)
    s_barrier
    v_mov_b32 v70, 73728
    ds_read_b128 v[72:75], v70
    ds_read_b128 v[76:79], v70 offset:16
    ds_read_b128 v[80:83], v70 offset:32
    ds_read_b128 v[84:87], v70 offset:48
    ds_read_b32 v88, v193
    ds_read_b32 v89, v193 offset:32
    ds_read_b128 v[20:23], v184
    ds_read_b128 v[24:27], v184 offset:4096
    ds_read_b128 v[28:31], v185
    ds_read_b128 v[32:35], v185 offset:4096
    ds_read_b128 v[36:39], v186
    ds_read_b128 v[40:43], v186 offset:4096
    ds_read_b128 v[44:47], v187
    ds_read_b128 v[48:51], v187 offset:4096
    s_waitcnt lgkmcnt(8)
    v_max3_f32 v90, v72, v74, v76
    v_max3_f32 v91, v80, v82, v84
    v_max_f32 v90, v90, v78
    v_max_f32 v91, v91, v86
    v_sub_f32 v72, v72, v90
    v_sub_f32 v74, v74, v90
    v_sub_f32 v76, v76, v90
    v_sub_f32 v78, v78, v90
    v_sub_f32 v88, v88, v90
    v_sub_f32 v80, v80, v91
    v_sub_f32 v82, v82, v91
    v_sub_f32 v84, v84, v91
    v_sub_f32 v86, v86, v91
    v_sub_f32 v89, v89, v91
    s_waitcnt lgkmcnt(6)
    v_mfma_f32_16x16x32_bf16 v[60:63], v[20:23], v[100:103], 0
    v_mfma_f32_16x16x32_bf16 v[64:67], v[24:27], v[100:103], 0
    v_exp_f32 v72, v72
    v_exp_f32 v74, v74
    v_exp_f32 v76, v76
    s_waitcnt lgkmcnt(4)
    v_mfma_f32_16x16x32_bf16 v[60:63], v[28:31], v[104:107], v[60:63]
    v_mfma_f32_16x16x32_bf16 v[64:67], v[32:35], v[104:107], v[64:67]
    v_exp_f32 v78, v78
    v_exp_f32 v80, v80
    v_exp_f32 v82, v82
    s_waitcnt lgkmcnt(2)
    v_mfma_f32_16x16x32_bf16 v[60:63], v[36:39], v[108:111], v[60:63]
    v_mfma_f32_16x16x32_bf16 v[64:67], v[40:43], v[108:111], v[64:67]
    v_exp_f32 v84, v84
    v_exp_f32 v86, v86
    v_exp_f32 v88, v88
    s_waitcnt lgkmcnt(0)
    v_mfma_f32_16x16x32_bf16 v[60:63], v[44:47], v[112:115], v[60:63]
    v_mfma_f32_16x16x32_bf16 v[64:67], v[48:51], v[112:115], v[64:67]
    v_exp_f32 v89, v89
    v_cmp_gt_u32 vcc, 32, v2
    v_mul_f32 v73, v72, v73
    v_mul_f32 v81, v80, v81
    v_fmac_f32 v73, v74, v75
    v_fmac_f32 v81, v82, v83
    v_fmac_f32 v73, v76, v77
    v_fmac_f32 v81, v84, v85
    v_fmac_f32 v73, v78, v79
    v_fmac_f32 v81, v86, v87
    v_rcp_f32 v73, v73
    v_rcp_f32 v81, v81
    v_add_f32 v60, v60, v61
    v_add_f32 v62, v62, v63
    v_add_f32 v64, v64, v65
    v_add_f32 v66, v66, v67
    v_mul_f32 v88, v88, v73
    v_mul_f32 v89, v89, v81
    v_add_f32 v60, v60, v62
    v_add_f32 v64, v64, v66
    v_mul_f32 v60, v60, v88
    v_mul_f32 v64, v64, v89
    s_nop 1
    v_permlane32_swap_b32 v60, v64
    s_nop 0
    v_add_f32 v60, v60, v64
    v_mov_b32 v61, v60
    s_nop 1
    v_permlane16_swap_b32 v61, v60
    s_nop 0
    v_add_f32 v60, v60, v61
    v_cvt_pk_bf16_f32 v60, v60, v60
    ds_write_b16 v188, v60
    s_waitcnt lgkmcnt(0)
    s_barrier
    s_cmp_lg_u32 s3, 0
    s_cbranch_scc1 L_a_fin
    ds_read_b128 v[60:63], v189
    s_waitcnt lgkmcnt(0)
    v_min_u32 v60, -2, v60
    v_min_u32 v61, -2, v61
    v_min_u32 v62, -2, v62
    v_min_u32 v63, -2, v63
    s_and_saveexec_b64 s[60:61], vcc
    buffer_store_dwordx4 v[60:63], v190, s[36:39], s68 offen sc1
    s_mov_b64 exec, s[60:61]
L_a_fin:
L_end:
    s_endpgm
L_code_end:
.section .rodata,"a"
.p2align 6
.amdhsa_kernel sequential_preLN__compressed_kv_cla__glu_gated_swiglu__decode_kernel
  .amdhsa_next_free_vgpr 256
  .amdhsa_next_free_sgpr 102
  .amdhsa_accum_offset 256
  .amdhsa_group_segment_fixed_size 0
  .amdhsa_kernarg_size 104
  .amdhsa_user_sgpr_count 2
  .amdhsa_user_sgpr_kernarg_segment_ptr 1
  .amdhsa_system_sgpr_workgroup_id_x 1
.end_amdhsa_kernel
```
